```python
import torch

def _softmax(x, axis=-1):
    return torch.softmax(x, dim=axis)
def _gelu(x):
    return torch.nn.functional.gelu(x, approximate="tanh")
def _silu(x):
    return torch.nn.functional.silu(x)
def _sigmoid(x):
    return torch.sigmoid(x)
def _layernorm(x, axis=-1, eps=1e-5):
    m = x.mean(dim=axis, keepdim=True)
    v = x.var(dim=axis, keepdim=True, unbiased=False)
    return (x - m) / torch.sqrt(v + eps)
def _scatter_add(tgt, idx, src, axis=0):
    return tgt.clone().index_add_(axis, idx, src)
def _segment_sum(src, seg, n):
    out = torch.zeros((n,) + src.shape[1:], dtype=src.dtype)
    return out.index_add_(0, seg, src)
def _pad(x, pw):
    flat = tuple(v for pair in reversed(pw) for v in pair)
    return torch.nn.functional.pad(x, flat)

kernel_name = 'concat_heads__mha_block_cached__sliding_block_cached__decode'

def setup_inputs():

    _w = (lambda a: (lambda t: t.to(torch.bfloat16) if t.is_floating_point() else t)(torch.as_tensor(a)))
    def _A_setup():
        B, Sq, D = 4, 1, 448
        H, Sk, Dh = 16, 4096, 256
        return {
            "x": _w((lambda *s: torch.randn(*s, dtype=torch.bfloat16) * 0.8)(B, Sq, D)),
            "k_cache": _w((lambda *s: torch.randn(*s, dtype=torch.bfloat16) * 1.6)(B, H, Sk, Dh)),
            "v_cache": _w((lambda *s: torch.randn(*s, dtype=torch.bfloat16) * 0.2)(B, H, Sk, Dh)),
            "wq": _w((lambda *s: torch.randn(*s, dtype=torch.bfloat16) * 1.6)(D, H * Dh) * (D ** -0.5)),
            "wo": _w((lambda *s: torch.randn(*s, dtype=torch.bfloat16) * 0.2)(H * Dh, D) * ((H * Dh) ** -0.5)),
        }
    _A_in = _A_setup()

    def _B_setup():
        B, Sq, D = 4, 1, 448
        Hq, Hkv, Sk, Dh = 16, 8, 4096, 256
        assert Hq % Hkv == 0, (Hq, Hkv)
        return {
            "x": _w((lambda *s: torch.randn(*s, dtype=torch.bfloat16) * 0.8)(B, Sq, D)),
            "k_cache": _w((lambda *s: torch.randn(*s, dtype=torch.bfloat16) * 1.6)(B, Hkv, Sk, Dh)),
            "v_cache": _w((lambda *s: torch.randn(*s, dtype=torch.bfloat16) * 0.2)(B, Hkv, Sk, Dh)),
            "wq": _w((lambda *s: torch.randn(*s, dtype=torch.bfloat16) * 1.6)(D, Hq * Dh) * (D ** -0.5)),
            "wo": _w((lambda *s: torch.randn(*s, dtype=torch.bfloat16) * 0.2)(Hq * Dh, D) * ((Hq * Dh) ** -0.5)),
        }
    _B_in = _B_setup()

    return {
        "A_x": _A_in["x"],
        "A_k_cache": _A_in["k_cache"],
        "A_v_cache": _A_in["v_cache"],
        "A_wq": _A_in["wq"],
        "A_wo": _A_in["wo"],
        "B_x": _B_in["x"],
        "B_k_cache": _B_in["k_cache"],
        "B_v_cache": _B_in["v_cache"],
        "B_wq": _B_in["wq"],
        "B_wo": _B_in["wo"],
    }

def reference(A_x, A_k_cache, A_v_cache, A_wq, A_wo, B_x, B_k_cache, B_v_cache, B_wq, B_wo):
    def _A_ref(x, k_cache, v_cache, wq, wo):
        B, Sq, D = x.shape
        H, Dh = 16, 256
        q = (lambda x, *d: x.permute(*d))((x @ wq).reshape(B, Sq, H, Dh), 0, 2, 1, 3)
        scores = torch.einsum("bhqd,bhkd->bhqk", q, k_cache) * (Dh ** -0.5)
        p = _softmax(scores, axis=-1)
        o = torch.einsum("bhqk,bhkd->bhqd", p, v_cache)
        return (lambda x, *d: x.permute(*d))(o, 0, 2, 1, 3).reshape(B, Sq, H * Dh) @ wo

    def _B_ref(x, k_cache, v_cache, wq, wo):
        B, Sq, D = x.shape
        Hq, Dh = 16, 256
        Hkv, Sk = k_cache.shape[1], k_cache.shape[2]
        W = min(4096, max(256, Sk // 4))
        rep = Hq // Hkv
        q = (lambda x, *d: x.permute(*d))((x @ wq).reshape(B, Sq, Hq, Dh), 0, 2, 1, 3)
        k = (lambda x, n, axis: torch.repeat_interleave(x, n, dim=axis))(k_cache[:, :, Sk - W:, :], rep, axis=1)
        v = (lambda x, n, axis: torch.repeat_interleave(x, n, dim=axis))(v_cache[:, :, Sk - W:, :], rep, axis=1)
        scores = torch.einsum("bhqd,bhkd->bhqk", q, k) * (Dh ** -0.5)
        p = _softmax(scores, axis=-1)
        o = torch.einsum("bhqk,bhkd->bhqd", p, v)
        return (lambda x, *d: x.permute(*d))(o, 0, 2, 1, 3).reshape(B, Sq, Hq * Dh) @ wo

    a = _A_ref(A_x, A_k_cache, A_v_cache, A_wq, A_wo)
    b = _B_ref(B_x, B_k_cache, B_v_cache, B_wq, B_wo)
    return torch.concatenate([a, b], axis=-1)
```

```asm
; @launch grid=(256,1,1) block=(384,1,1) lds=96256
.amdgcn_target "amdgcn-amd-amdhsa--gfx950"
.text
.globl concat_heads__mha_block_cached__sliding_block_cached__decode_kernel
.p2align 8
.type concat_heads__mha_block_cached__sliding_block_cached__decode_kernel,@function
concat_heads__mha_block_cached__sliding_block_cached__decode_kernel:
    s_load_dwordx16 s[4:19], s[0:1], 0
    s_load_dwordx8 s[20:27], s[0:1], 64
    s_load_dwordx2 s[28:29], s[0:1], 96
    s_cmp_ge_u32 s2, 256
    s_cbranch_scc1 L_end
    v_lshrrev_b32 v56, 6, v0
    v_and_b32 v0, 63, v0
    v_readfirstlane_b32 s3, v56
    v_lshrrev_b32 v60, 4, v0
    v_and_b32 v61, 15, v0
    s_and_b32 s72, s2, 7
    s_lshr_b32 s73, s2, 3
    s_lshr_b32 s78, s2, 7
    s_lshl1_add_u32 s74, s72, s78
    s_bfe_u32 s75, s73, 0x20002
    s_cmp_ge_u32 s3, 4
    s_cbranch_scc1 L_helper
    v_lshl_add_u32 v1, v56, 2, v60
    v_lshl_add_u32 v1, v1, 5, v61
    v_lshlrev_b32 v1, 4, v1
    s_lshl4_add_u32 s40, s75, s74
    s_and_b32 s41, s73, 3
    s_lshl_b32 s40, s40, 6
    s_add_u32 s40, s40, s41
    s_lshl_b32 s40, s40, 15
    s_mov_b32 s34, 1998848
    s_mov_b32 s35, 0x20000
    s_lshl_b32 s101, s75, 19
    s_mov_b32 s76, s101
    s_waitcnt lgkmcnt(0)
    s_add_u32 s32, s6, s40
    s_addc_u32 s33, s7, 0
    buffer_load_dwordx4 v[128:131], v1, s[32:35], s76 offen offset:0 nt
    buffer_load_dwordx4 v[132:135], v1, s[32:35], s76 offen offset:256 nt
    s_addk_i32 s76, 8192
    buffer_load_dwordx4 v[136:139], v1, s[32:35], s76 offen offset:0 nt
    buffer_load_dwordx4 v[140:143], v1, s[32:35], s76 offen offset:256 nt
    s_addk_i32 s76, 8192
    buffer_load_dwordx4 v[64:67], v1, s[32:35], s76 offen offset:0 nt
    s_load_dwordx2 s[56:57], s[28:29], 933888
    s_add_u32 s36, s8, s40
    s_addc_u32 s37, s9, 0
    s_mov_b32 s38, 1998848
    s_mov_b32 s39, 0x20000
    s_lshl2_add_u32 s82, s74, s75
    s_lshl3_add_u32 s82, s82, s41
    s_lshl_b32 s83, s72, 6
    s_add_u32 s83, s83, s73
    s_add_u32 s83, s83, 512
    s_andn2_b32 s44, s73, 7
    s_add_u32 s44, s44, s72
    s_xor_b32 s44, s44, 0
    s_lshl_b32 s44, s44, 21
    s_and_b32 s45, s73, 7
    s_lshl_b32 s45, s45, 14
    s_add_u32 s44, s44, s45
    s_add_u32 s44, s44, 0x180000
    s_add_u32 s40, s16, s44
    s_addc_u32 s41, s17, 0
    s_mov_b32 s42, 409600
    s_mov_b32 s43, 0x20000
    s_add_u32 s44, s18, s44
    s_addc_u32 s45, s19, 0
    s_mov_b32 s46, 409600
    s_mov_b32 s47, 0x20000
    s_mov_b32 s60, s28
    s_mov_b32 s61, s29
    s_mov_b32 s62, 1966080
    s_mov_b32 s63, 0x20000
    s_mov_b32 s48, s12
    s_mov_b32 s49, s13
    s_mov_b32 s50, 3670016
    s_mov_b32 s51, 0x20000
    s_mov_b32 s52, s22
    s_mov_b32 s53, s23
    s_mov_b32 s54, 3670016
    s_mov_b32 s55, 0x20000
    s_mul_i32 s78, s73, 37
    s_lshr_b32 s78, s78, 8
    s_mul_i32 s79, s78, 7
    s_sub_u32 s79, s73, s79
    s_lshl_b32 s80, s72, 2
    s_add_u32 s78, s78, s80
    s_mul_i32 s86, s78, 114688
    s_lshl_b32 s80, s79, 7
    s_add_u32 s86, s86, s80
    s_lshr_b32 s84, s78, 1
    s_lshl_b32 s84, s84, 14
    s_and_b32 s80, s78, 1
    s_lshl_b32 s80, s80, 12
    s_add_u32 s84, s84, s80
    s_add_u32 s84, s84, 294912
    s_lshl_b32 s85, s79, 14
    s_lshl_b32 s80, s78, 6
    s_add_u32 s85, s85, s80
    s_add_u32 s85, s85, 1048576
    s_mul_i32 s78, s3, 28672
    s_add_u32 s86, s86, s78
    s_lshl_b32 s78, s3, 11
    s_add_u32 s85, s85, s78
    s_xor_b32 s78, s72, 0
    s_sub_i32 s78, s78, s72
    s_mul_i32 s78, s78, 458752
    s_add_u32 s69, s86, s78
    s_cmp_ge_u32 s73, 28
    s_cselect_b32 s86, 1073741824, s86
    s_cselect_b32 s69, 1073741824, s69
    s_cselect_b32 s84, 1073741824, s84
    s_mul_i32 s95, s73, 1
    s_mul_i32 s78, s72, 4
    s_add_u32 s95, s95, s78
    s_and_b32 s95, s95, 1
    s_lshr_b32 s78, s95, 1
    s_mul_i32 s78, s78, 14
    s_add_u32 s95, s95, s78
    s_lshl_b32 s95, s95, 13
    s_mov_b32 s87, 1035512379
    s_mov_b32 s90, 0xcccccccc
    s_mov_b32 s91, 0xcccccccc
    s_mov_b32 s92, 0xaaaaaaaa
    s_mov_b32 s93, 0xaaaaaaaa
    s_and_b64 s[98:99], s[90:91], s[92:93]
    s_mov_b32 s100, 98304
    s_mov_b32 s70, 1998847
    v_bfe_u32 v54, v0, 1, 2
    v_mov_b32 v56, 0xffff
    v_mov_b32 v55, 0xffff0000
    v_cndmask_b32 v56, v56, v55, s[92:93]
    v_cmp_eq_u32 vcc, 0, v54
    s_nop 1
    v_cndmask_b32 v2, 0, v56, vcc
    v_cmp_eq_u32 vcc, 1, v54
    s_nop 1
    v_cndmask_b32 v3, 0, v56, vcc
    v_cmp_eq_u32 vcc, 2, v54
    s_nop 1
    v_cndmask_b32 v4, 0, v56, vcc
    v_cmp_eq_u32 vcc, 3, v54
    s_nop 1
    v_cndmask_b32 v5, 0, v56, vcc
    v_lshlrev_b32 v57, 4, v61
    v_mov_b32 v54, 46596
    s_mul_i32 s64, s3, 12288
    s_add_u32 s64, s64, 46848
    s_and_b32 s78, s73, 7
    s_cmp_eq_u32 s78, 3
    s_cselect_b64 vcc, -1, 0
    s_waitcnt vmcnt(4)
    buffer_load_dwordx4 v[68:71], v1, s[32:35], s76 offen offset:256 nt
    s_addk_i32 s76, 8192
    s_waitcnt vmcnt(4)
    buffer_load_dwordx4 v[72:75], v1, s[32:35], s76 offen offset:0 nt
    s_waitcnt vmcnt(4)
    buffer_load_dwordx4 v[76:79], v1, s[32:35], s76 offen offset:256 nt
    s_add_u32 s76, s76, 106496
    s_bitset0_b32 s76, 21
    s_waitcnt vmcnt(4)
    buffer_load_dwordx4 v[80:83], v1, s[32:35], s76 offen offset:0 nt
    s_waitcnt vmcnt(4)
    buffer_load_dwordx4 v[84:87], v1, s[32:35], s76 offen offset:256 nt
    s_addk_i32 s76, 8192
    s_waitcnt vmcnt(4)
    buffer_load_dwordx4 v[88:91], v1, s[32:35], s76 offen offset:0 nt
    s_waitcnt vmcnt(4)
    buffer_load_dwordx4 v[92:95], v1, s[32:35], s76 offen offset:256 nt
    s_addk_i32 s76, 8192
    s_waitcnt vmcnt(4)
    buffer_load_dwordx4 v[96:99], v1, s[32:35], s76 offen offset:0 nt
    s_waitcnt vmcnt(4)
    buffer_load_dwordx4 v[100:103], v1, s[32:35], s76 offen offset:256 nt
    s_addk_i32 s76, 8192
    s_waitcnt vmcnt(5)
    s_cbranch_vccnz L_boost14
    s_waitcnt vmcnt(4)
L_boost14:
    buffer_load_dwordx4 v[104:107], v1, s[32:35], s76 offen offset:0 nt
    s_waitcnt vmcnt(5)
    s_cbranch_vccnz L_boost15
    s_waitcnt vmcnt(4)
L_boost15:
    buffer_load_dwordx4 v[108:111], v1, s[32:35], s76 offen offset:256 nt
    s_add_u32 s76, s76, 106496
    s_bitset0_b32 s76, 21
    s_waitcnt vmcnt(5)
    s_cbranch_vccnz L_boost16
    s_waitcnt vmcnt(4)
L_boost16:
    buffer_load_dwordx4 v[112:115], v1, s[32:35], s76 offen offset:0 nt
    s_waitcnt vmcnt(5)
    s_cbranch_vccnz L_boost17
    s_waitcnt vmcnt(4)
L_boost17:
    buffer_load_dwordx4 v[116:119], v1, s[32:35], s76 offen offset:256 nt
    s_addk_i32 s76, 8192
    s_waitcnt vmcnt(5)
    s_cbranch_vccnz L_boost18
    s_waitcnt vmcnt(4)
L_boost18:
    buffer_load_dwordx4 v[120:123], v1, s[32:35], s76 offen offset:0 nt
    s_waitcnt vmcnt(5)
    s_cbranch_vccnz L_boost19
    s_waitcnt vmcnt(4)
L_boost19:
    buffer_load_dwordx4 v[124:127], v1, s[32:35], s76 offen offset:256 nt
    s_addk_i32 s76, 8192
    s_waitcnt vmcnt(5)
    s_cbranch_vccnz L_boost20
    s_waitcnt vmcnt(4)
L_boost20:
    buffer_load_dwordx4 v[144:147], v1, s[32:35], s76 offen offset:0 nt
    s_waitcnt vmcnt(5)
    s_cbranch_vccnz L_boost21
    s_waitcnt vmcnt(4)
L_boost21:
    buffer_load_dwordx4 v[148:151], v1, s[32:35], s76 offen offset:256 nt
    s_addk_i32 s76, 8192
    s_waitcnt vmcnt(5)
    s_cbranch_vccnz L_boost22
    s_waitcnt vmcnt(4)
L_boost22:
    buffer_load_dwordx4 v[152:155], v1, s[32:35], s76 offen offset:0 nt
    s_waitcnt vmcnt(5)
    s_cbranch_vccnz L_boost23
    s_waitcnt vmcnt(4)
L_boost23:
    buffer_load_dwordx4 v[156:159], v1, s[32:35], s76 offen offset:256 nt
    s_add_u32 s76, s76, 106496
    s_bitset0_b32 s76, 21
    s_waitcnt lgkmcnt(0)
    s_add_u32 s56, s56, 2654435769
    s_addc_u32 s57, s57, 2135587861
    s_lshr_b32 s58, s57, 4
    s_getreg_b32 s78, hwreg(HW_REG_XCC_ID, 0, 4)
    s_lshl_b32 s59, s58, 4
    s_or_b32 s59, s59, s78
    s_and_b32 s65, s56, 0xfff
    s_bfe_u32 s66, s56, 0xc000c
    s_and_b32 s67, s58, 0xfff
    s_bfe_u32 s68, s58, 0xc000c
    s_waitcnt vmcnt(5)
    s_cbranch_vccnz L_boost24
    s_waitcnt vmcnt(4)
L_boost24:
    buffer_load_dwordx4 v[160:163], v1, s[32:35], s76 offen offset:0 nt
    s_waitcnt vmcnt(5)
    s_cbranch_vccnz L_boost25
    s_waitcnt vmcnt(4)
L_boost25:
    buffer_load_dwordx4 v[164:167], v1, s[32:35], s76 offen offset:256 nt
    s_addk_i32 s76, 8192
    s_waitcnt vmcnt(5)
    s_cbranch_vccnz L_boost26
    s_waitcnt vmcnt(4)
L_boost26:
    buffer_load_dwordx4 v[168:171], v1, s[32:35], s76 offen offset:0 nt
    s_waitcnt vmcnt(5)
    s_cbranch_vccnz L_boost27
    s_waitcnt vmcnt(4)
L_boost27:
    buffer_load_dwordx4 v[172:175], v1, s[32:35], s76 offen offset:256 nt
    s_addk_i32 s76, 8192
    s_waitcnt vmcnt(5)
    s_cbranch_vccnz L_boost28
    s_waitcnt vmcnt(4)
L_boost28:
    buffer_load_dwordx4 v[176:179], v1, s[32:35], s76 offen offset:0 nt
    s_waitcnt vmcnt(5)
    s_cbranch_vccnz L_boost29
    s_waitcnt vmcnt(4)
L_boost29:
    buffer_load_dwordx4 v[180:183], v1, s[32:35], s76 offen offset:256 nt
    s_addk_i32 s76, 8192
    s_waitcnt vmcnt(5)
    s_cbranch_vccnz L_boost30
    s_waitcnt vmcnt(4)
L_boost30:
    buffer_load_dwordx4 v[184:187], v1, s[32:35], s76 offen offset:0 nt
    s_waitcnt vmcnt(5)
    s_cbranch_vccnz L_boost31
    s_waitcnt vmcnt(4)
L_boost31:
    buffer_load_dwordx4 v[188:191], v1, s[32:35], s76 offen offset:256 nt
    s_add_u32 s76, s76, 106496
    s_bitset0_b32 s76, 21
    s_waitcnt vmcnt(5)
    s_cbranch_vccnz L_boost32
    s_waitcnt vmcnt(4)
L_boost32:
    buffer_load_dwordx4 v[192:195], v1, s[32:35], s76 offen offset:0 nt
    s_waitcnt vmcnt(5)
    s_cbranch_vccnz L_boost33
    s_waitcnt vmcnt(4)
L_boost33:
    buffer_load_dwordx4 v[196:199], v1, s[32:35], s76 offen offset:256 nt
    s_addk_i32 s76, 8192
    s_waitcnt vmcnt(5)
    s_cbranch_vccnz L_boost34
    s_waitcnt vmcnt(4)
L_boost34:
    buffer_load_dwordx4 v[200:203], v1, s[32:35], s76 offen offset:0 nt
    s_waitcnt vmcnt(5)
    s_cbranch_vccnz L_boost35
    s_waitcnt vmcnt(4)
L_boost35:
    buffer_load_dwordx4 v[204:207], v1, s[32:35], s76 offen offset:256 nt
    s_addk_i32 s76, 8192
    s_waitcnt vmcnt(5)
    s_cbranch_vccnz L_boost36
    s_waitcnt vmcnt(4)
L_boost36:
    buffer_load_dwordx4 v[208:211], v1, s[32:35], s76 offen offset:0 nt
    s_waitcnt vmcnt(5)
    s_cbranch_vccnz L_boost37
    s_waitcnt vmcnt(4)
L_boost37:
    buffer_load_dwordx4 v[212:215], v1, s[32:35], s76 offen offset:256 nt
    s_addk_i32 s76, 8192
    s_waitcnt vmcnt(4)
    buffer_load_dwordx4 v[216:219], v1, s[32:35], s76 offen offset:0 nt
    s_waitcnt vmcnt(4)
    buffer_load_dwordx4 v[220:223], v1, s[32:35], s76 offen offset:256 nt
    s_add_u32 s76, s76, 106496
    s_bitset0_b32 s76, 21
    s_waitcnt vmcnt(4)
    buffer_load_dwordx4 v[224:227], v1, s[32:35], s76 offen offset:0 nt
    s_waitcnt vmcnt(4)
    buffer_load_dwordx4 v[228:231], v1, s[32:35], s76 offen offset:256 nt
    s_addk_i32 s76, 8192
    s_waitcnt vmcnt(4)
    buffer_load_dwordx4 v[232:235], v1, s[32:35], s76 offen offset:0 nt
    s_waitcnt vmcnt(4)
    buffer_load_dwordx4 v[236:239], v1, s[32:35], s76 offen offset:256 nt
    s_addk_i32 s76, 8192
    s_waitcnt vmcnt(4)
    buffer_load_dwordx4 v[240:243], v1, s[32:35], s76 offen offset:0 nt
    s_waitcnt vmcnt(4)
    buffer_load_dwordx4 v[244:247], v1, s[32:35], s76 offen offset:256 nt
    s_addk_i32 s76, 8192
    s_waitcnt vmcnt(4)
    buffer_load_dwordx4 v[248:251], v1, s[32:35], s76 offen offset:0 nt
    s_waitcnt vmcnt(4)
    buffer_load_dwordx4 v[252:255], v1, s[32:35], s76 offen offset:256 nt
    s_add_u32 s76, s76, 106496
    s_bitset0_b32 s76, 21
    s_waitcnt vmcnt(4)
    s_add_u32 m0, s64, 256
    s_nop 0
    buffer_load_dwordx4 v1, s[32:35], s76 offen offset:0 nt lds
    s_waitcnt vmcnt(4)
    s_add_u32 m0, s64, 1024
    s_nop 0
    buffer_load_dwordx4 v1, s[32:35], s76 offen offset:256 nt lds
    s_addk_i32 s76, 8192
    s_waitcnt vmcnt(4)
    s_add_u32 m0, s64, 2304
    s_nop 0
    buffer_load_dwordx4 v1, s[32:35], s76 offen offset:0 nt lds
    s_waitcnt vmcnt(4)
    s_add_u32 m0, s64, 3072
    s_nop 0
    buffer_load_dwordx4 v1, s[32:35], s76 offen offset:256 nt lds
    s_addk_i32 s76, 8192
    s_waitcnt vmcnt(4)
    s_add_u32 m0, s64, 4352
    s_nop 0
    buffer_load_dwordx4 v1, s[32:35], s76 offen offset:0 nt lds
    s_waitcnt vmcnt(4)
    s_add_u32 m0, s64, 5120
    s_nop 0
    buffer_load_dwordx4 v1, s[32:35], s76 offen offset:256 nt lds
    s_addk_i32 s76, 8192
    s_waitcnt vmcnt(4)
    s_add_u32 m0, s64, 6400
    s_nop 0
    buffer_load_dwordx4 v1, s[32:35], s76 offen offset:0 nt lds
    s_waitcnt vmcnt(4)
    s_add_u32 m0, s64, 7168
    s_nop 0
    buffer_load_dwordx4 v1, s[32:35], s76 offen offset:256 nt lds
    s_add_u32 s76, s76, 106496
    s_bitset0_b32 s76, 21
    s_barrier
    ds_read_b128 v[6:9], v57 offset:46080
    ds_read_b128 v[10:13], v57 offset:46336
    ds_read_b128 v[14:17], v57 offset:45056
    ds_read_b128 v[18:21], v57 offset:45312
    ds_read_b128 v[22:25], v57 offset:45568
    ds_read_b128 v[26:29], v57 offset:45824
    ds_read2_b32 v[54:55], v54 offset0:0 offset1:1
    s_waitcnt vmcnt(4)
    s_add_u32 m0, s64, 8448
    s_nop 0
    buffer_load_dwordx4 v1, s[32:35], s76 offen offset:0 nt lds
    s_waitcnt vmcnt(4)
    s_add_u32 m0, s64, 9216
    s_nop 0
    buffer_load_dwordx4 v1, s[32:35], s76 offen offset:256 nt lds
    s_addk_i32 s76, 8192
    s_waitcnt vmcnt(4)
    s_add_u32 m0, s64, 10496
    s_nop 0
    buffer_load_dwordx4 v1, s[32:35], s76 offen offset:0 nt lds
    s_waitcnt vmcnt(4)
    s_add_u32 m0, s64, 11264
    s_nop 0
    buffer_load_dwordx4 v1, s[32:35], s76 offen offset:256 nt lds
    s_addk_i32 s76, 8192
    v_lshl_add_u32 v57, v0, 4, s64
    s_waitcnt lgkmcnt(0)
    v_readfirstlane_b32 s89, v54
    v_readfirstlane_b32 s71, v55
    v_mov_b32 v46, 0
    v_dot2c_f32_bf16 v46, v128, v6
    v_dot2c_f32_bf16 v46, v129, v7
    v_dot2c_f32_bf16 v46, v130, v8
    v_dot2c_f32_bf16 v46, v131, v9
    s_waitcnt vmcnt(4)
    buffer_load_dwordx4 v[128:131], v1, s[32:35], s76 offen offset:0 nt
    v_dot2c_f32_bf16 v46, v132, v10
    v_dot2c_f32_bf16 v46, v133, v11
    v_dot2c_f32_bf16 v46, v134, v12
    v_dot2c_f32_bf16 v46, v135, v13
    s_nop 2
    v_add_f32_dpp v48, v46, v46 row_ror:8 row_mask:0xf bank_mask:0x3
    s_waitcnt vmcnt(4)
    buffer_load_dwordx4 v[132:135], v1, s[32:35], s76 offen offset:256 nt
    s_addk_i32 s76, 8192
    v_mov_b32 v47, 0
    v_dot2c_f32_bf16 v47, v136, v6
    v_dot2c_f32_bf16 v47, v137, v7
    v_dot2c_f32_bf16 v47, v138, v8
    v_dot2c_f32_bf16 v47, v139, v9
    s_waitcnt vmcnt(4)
    buffer_load_dwordx4 v[136:139], v1, s[32:35], s76 offen offset:0 nt
    v_dot2c_f32_bf16 v47, v140, v10
    v_dot2c_f32_bf16 v47, v141, v11
    v_dot2c_f32_bf16 v47, v142, v12
    v_dot2c_f32_bf16 v47, v143, v13
    s_nop 2
    v_add_f32_dpp v48, v47, v47 row_ror:8 row_mask:0xf bank_mask:0xc
    s_nop 1
    v_add_f32_dpp v50, v48, v48 row_half_mirror row_mask:0xf bank_mask:0x5
    s_waitcnt vmcnt(4)
    buffer_load_dwordx4 v[140:143], v1, s[32:35], s76 offen offset:256 nt
    s_add_u32 s76, s76, 106496
    s_bitset0_b32 s76, 21
    v_mov_b32 v46, 0
    v_dot2c_f32_bf16 v46, v64, v6
    v_dot2c_f32_bf16 v46, v65, v7
    v_dot2c_f32_bf16 v46, v66, v8
    v_dot2c_f32_bf16 v46, v67, v9
    s_waitcnt vmcnt(4)
    buffer_load_dwordx4 v[64:67], v1, s[32:35], s76 offen offset:0 nt
    v_dot2c_f32_bf16 v46, v68, v10
    v_dot2c_f32_bf16 v46, v69, v11
    v_dot2c_f32_bf16 v46, v70, v12
    v_dot2c_f32_bf16 v46, v71, v13
    s_nop 2
    v_add_f32_dpp v48, v46, v46 row_ror:8 row_mask:0xf bank_mask:0x3
    s_waitcnt vmcnt(4)
    buffer_load_dwordx4 v[68:71], v1, s[32:35], s76 offen offset:256 nt
    s_addk_i32 s76, 8192
    v_mov_b32 v47, 0
    v_dot2c_f32_bf16 v47, v72, v6
    v_dot2c_f32_bf16 v47, v73, v7
    v_dot2c_f32_bf16 v47, v74, v8
    v_dot2c_f32_bf16 v47, v75, v9
    v_dot2c_f32_bf16 v47, v76, v10
    v_dot2c_f32_bf16 v47, v77, v11
    v_dot2c_f32_bf16 v47, v78, v12
    v_dot2c_f32_bf16 v47, v79, v13
    s_nop 2
    v_add_f32_dpp v48, v47, v47 row_ror:8 row_mask:0xf bank_mask:0xc
    s_nop 1
    v_add_f32_dpp v50, v48, v48 row_half_mirror row_mask:0xf bank_mask:0xa
    v_mov_b32_dpp v52, v30 quad_perm:[1,2,3,0] row_mask:0xf bank_mask:0xf
    s_nop 0
    v_add_f32_dpp v50, v50, v50 quad_perm:[2,3,0,1] row_mask:0xf bank_mask:0xf
    s_nop 1
    v_add_f32_dpp v50, v50, v50 quad_perm:[1,0,3,2] row_mask:0xf bank_mask:0xf
    v_cndmask_b32 v30, v52, v50, s[98:99]
    v_mov_b32 v46, 0
    v_dot2c_f32_bf16 v46, v80, v6
    v_dot2c_f32_bf16 v46, v81, v7
    v_dot2c_f32_bf16 v46, v82, v8
    v_dot2c_f32_bf16 v46, v83, v9
    v_dot2c_f32_bf16 v46, v84, v10
    v_dot2c_f32_bf16 v46, v85, v11
    v_dot2c_f32_bf16 v46, v86, v12
    v_dot2c_f32_bf16 v46, v87, v13
    s_nop 2
    v_add_f32_dpp v48, v46, v46 row_ror:8 row_mask:0xf bank_mask:0x3
    v_mov_b32 v47, 0
    v_dot2c_f32_bf16 v47, v88, v6
    v_dot2c_f32_bf16 v47, v89, v7
    v_dot2c_f32_bf16 v47, v90, v8
    v_dot2c_f32_bf16 v47, v91, v9
    v_dot2c_f32_bf16 v47, v92, v10
    v_dot2c_f32_bf16 v47, v93, v11
    v_dot2c_f32_bf16 v47, v94, v12
    v_dot2c_f32_bf16 v47, v95, v13
    s_nop 2
    v_add_f32_dpp v48, v47, v47 row_ror:8 row_mask:0xf bank_mask:0xc
    s_nop 1
    v_add_f32_dpp v50, v48, v48 row_half_mirror row_mask:0xf bank_mask:0x5
    s_waitcnt vmcnt(4)
    buffer_load_dwordx4 v[72:75], v1, s[32:35], s76 offen offset:0 nt
    v_mov_b32 v46, 0
    v_dot2c_f32_bf16 v46, v96, v6
    v_dot2c_f32_bf16 v46, v97, v7
    v_dot2c_f32_bf16 v46, v98, v8
    v_dot2c_f32_bf16 v46, v99, v9
    v_dot2c_f32_bf16 v46, v100, v10
    v_dot2c_f32_bf16 v46, v101, v11
    v_dot2c_f32_bf16 v46, v102, v12
    v_dot2c_f32_bf16 v46, v103, v13
    s_nop 2
    v_add_f32_dpp v48, v46, v46 row_ror:8 row_mask:0xf bank_mask:0x3
    v_mov_b32 v47, 0
    v_dot2c_f32_bf16 v47, v104, v6
    v_dot2c_f32_bf16 v47, v105, v7
    v_dot2c_f32_bf16 v47, v106, v8
    v_dot2c_f32_bf16 v47, v107, v9
    v_dot2c_f32_bf16 v47, v108, v10
    v_dot2c_f32_bf16 v47, v109, v11
    v_dot2c_f32_bf16 v47, v110, v12
    v_dot2c_f32_bf16 v47, v111, v13
    s_nop 2
    v_add_f32_dpp v48, v47, v47 row_ror:8 row_mask:0xf bank_mask:0xc
    s_nop 1
    v_add_f32_dpp v50, v48, v48 row_half_mirror row_mask:0xf bank_mask:0xa
    v_mov_b32_dpp v52, v31 quad_perm:[1,2,3,0] row_mask:0xf bank_mask:0xf
    s_nop 0
    v_add_f32_dpp v50, v50, v50 quad_perm:[2,3,0,1] row_mask:0xf bank_mask:0xf
    s_nop 1
    v_add_f32_dpp v50, v50, v50 quad_perm:[1,0,3,2] row_mask:0xf bank_mask:0xf
    v_cndmask_b32 v31, v52, v50, s[98:99]
    v_mov_b32 v46, 0
    v_dot2c_f32_bf16 v46, v112, v6
    v_dot2c_f32_bf16 v46, v113, v7
    v_dot2c_f32_bf16 v46, v114, v8
    v_dot2c_f32_bf16 v46, v115, v9
    v_dot2c_f32_bf16 v46, v116, v10
    v_dot2c_f32_bf16 v46, v117, v11
    v_dot2c_f32_bf16 v46, v118, v12
    v_dot2c_f32_bf16 v46, v119, v13
    s_nop 2
    v_add_f32_dpp v48, v46, v46 row_ror:8 row_mask:0xf bank_mask:0x3
    s_waitcnt vmcnt(4)
    buffer_load_dwordx4 v[76:79], v1, s[32:35], s76 offen offset:256 nt
    s_addk_i32 s76, 8192
    v_mov_b32 v47, 0
    v_dot2c_f32_bf16 v47, v120, v6
    v_dot2c_f32_bf16 v47, v121, v7
    v_dot2c_f32_bf16 v47, v122, v8
    v_dot2c_f32_bf16 v47, v123, v9
    v_dot2c_f32_bf16 v47, v124, v10
    v_dot2c_f32_bf16 v47, v125, v11
    v_dot2c_f32_bf16 v47, v126, v12
    v_dot2c_f32_bf16 v47, v127, v13
    s_nop 2
    v_add_f32_dpp v48, v47, v47 row_ror:8 row_mask:0xf bank_mask:0xc
    s_nop 1
    v_add_f32_dpp v50, v48, v48 row_half_mirror row_mask:0xf bank_mask:0x5
    v_mov_b32 v46, 0
    v_dot2c_f32_bf16 v46, v144, v6
    v_dot2c_f32_bf16 v46, v145, v7
    v_dot2c_f32_bf16 v46, v146, v8
    v_dot2c_f32_bf16 v46, v147, v9
    v_dot2c_f32_bf16 v46, v148, v10
    v_dot2c_f32_bf16 v46, v149, v11
    v_dot2c_f32_bf16 v46, v150, v12
    v_dot2c_f32_bf16 v46, v151, v13
    s_nop 2
    v_add_f32_dpp v48, v46, v46 row_ror:8 row_mask:0xf bank_mask:0x3
    v_mov_b32 v47, 0
    v_dot2c_f32_bf16 v47, v152, v6
    v_dot2c_f32_bf16 v47, v153, v7
    v_dot2c_f32_bf16 v47, v154, v8
    v_dot2c_f32_bf16 v47, v155, v9
    v_dot2c_f32_bf16 v47, v156, v10
    v_dot2c_f32_bf16 v47, v157, v11
    v_dot2c_f32_bf16 v47, v158, v12
    v_dot2c_f32_bf16 v47, v159, v13
    s_nop 2
    v_add_f32_dpp v48, v47, v47 row_ror:8 row_mask:0xf bank_mask:0xc
    s_nop 1
    v_add_f32_dpp v50, v48, v48 row_half_mirror row_mask:0xf bank_mask:0xa
    v_mov_b32_dpp v52, v32 quad_perm:[1,2,3,0] row_mask:0xf bank_mask:0xf
    s_nop 0
    v_add_f32_dpp v50, v50, v50 quad_perm:[2,3,0,1] row_mask:0xf bank_mask:0xf
    s_nop 1
    v_add_f32_dpp v50, v50, v50 quad_perm:[1,0,3,2] row_mask:0xf bank_mask:0xf
    v_cndmask_b32 v32, v52, v50, s[98:99]
    s_waitcnt vmcnt(4)
    buffer_load_dwordx4 v[80:83], v1, s[32:35], s76 offen offset:0 nt
    v_mov_b32 v46, 0
    v_dot2c_f32_bf16 v46, v160, v6
    v_dot2c_f32_bf16 v46, v161, v7
    v_dot2c_f32_bf16 v46, v162, v8
    v_dot2c_f32_bf16 v46, v163, v9
    v_dot2c_f32_bf16 v46, v164, v10
    v_dot2c_f32_bf16 v46, v165, v11
    v_dot2c_f32_bf16 v46, v166, v12
    v_dot2c_f32_bf16 v46, v167, v13
    s_nop 2
    v_add_f32_dpp v48, v46, v46 row_ror:8 row_mask:0xf bank_mask:0x3
    v_mov_b32 v47, 0
    v_dot2c_f32_bf16 v47, v168, v6
    v_dot2c_f32_bf16 v47, v169, v7
    v_dot2c_f32_bf16 v47, v170, v8
    v_dot2c_f32_bf16 v47, v171, v9
    v_dot2c_f32_bf16 v47, v172, v10
    v_dot2c_f32_bf16 v47, v173, v11
    v_dot2c_f32_bf16 v47, v174, v12
    v_dot2c_f32_bf16 v47, v175, v13
    s_nop 2
    v_add_f32_dpp v48, v47, v47 row_ror:8 row_mask:0xf bank_mask:0xc
    s_nop 1
    v_add_f32_dpp v50, v48, v48 row_half_mirror row_mask:0xf bank_mask:0x5
    v_mov_b32 v46, 0
    v_dot2c_f32_bf16 v46, v176, v6
    v_dot2c_f32_bf16 v46, v177, v7
    v_dot2c_f32_bf16 v46, v178, v8
    v_dot2c_f32_bf16 v46, v179, v9
    v_dot2c_f32_bf16 v46, v180, v10
    v_dot2c_f32_bf16 v46, v181, v11
    v_dot2c_f32_bf16 v46, v182, v12
    v_dot2c_f32_bf16 v46, v183, v13
    s_nop 2
    v_add_f32_dpp v48, v46, v46 row_ror:8 row_mask:0xf bank_mask:0x3
    s_waitcnt vmcnt(4)
    buffer_load_dwordx4 v[84:87], v1, s[32:35], s76 offen offset:256 nt
    s_addk_i32 s76, 8192
    v_mov_b32 v47, 0
    v_dot2c_f32_bf16 v47, v184, v6
    v_dot2c_f32_bf16 v47, v185, v7
    v_dot2c_f32_bf16 v47, v186, v8
    v_dot2c_f32_bf16 v47, v187, v9
    v_dot2c_f32_bf16 v47, v188, v10
    v_dot2c_f32_bf16 v47, v189, v11
    v_dot2c_f32_bf16 v47, v190, v12
    v_dot2c_f32_bf16 v47, v191, v13
    s_nop 2
    v_add_f32_dpp v48, v47, v47 row_ror:8 row_mask:0xf bank_mask:0xc
    s_nop 1
    v_add_f32_dpp v50, v48, v48 row_half_mirror row_mask:0xf bank_mask:0xa
    v_mov_b32_dpp v52, v33 quad_perm:[1,2,3,0] row_mask:0xf bank_mask:0xf
    s_nop 0
    v_add_f32_dpp v50, v50, v50 quad_perm:[2,3,0,1] row_mask:0xf bank_mask:0xf
    s_nop 1
    v_add_f32_dpp v50, v50, v50 quad_perm:[1,0,3,2] row_mask:0xf bank_mask:0xf
    v_cndmask_b32 v33, v52, v50, s[98:99]
    v_mov_b32 v46, 0
    v_dot2c_f32_bf16 v46, v192, v6
    v_dot2c_f32_bf16 v46, v193, v7
    v_dot2c_f32_bf16 v46, v194, v8
    v_dot2c_f32_bf16 v46, v195, v9
    v_dot2c_f32_bf16 v46, v196, v10
    v_dot2c_f32_bf16 v46, v197, v11
    v_dot2c_f32_bf16 v46, v198, v12
    v_dot2c_f32_bf16 v46, v199, v13
    s_nop 2
    v_add_f32_dpp v48, v46, v46 row_ror:8 row_mask:0xf bank_mask:0x3
    v_mov_b32 v47, 0
    v_dot2c_f32_bf16 v47, v200, v6
    v_dot2c_f32_bf16 v47, v201, v7
    v_dot2c_f32_bf16 v47, v202, v8
    v_dot2c_f32_bf16 v47, v203, v9
    v_dot2c_f32_bf16 v47, v204, v10
    v_dot2c_f32_bf16 v47, v205, v11
    v_dot2c_f32_bf16 v47, v206, v12
    v_dot2c_f32_bf16 v47, v207, v13
    s_nop 2
    v_add_f32_dpp v48, v47, v47 row_ror:8 row_mask:0xf bank_mask:0xc
    s_nop 1
    v_add_f32_dpp v50, v48, v48 row_half_mirror row_mask:0xf bank_mask:0x5
    s_waitcnt vmcnt(4)
    buffer_load_dwordx4 v[88:91], v1, s[32:35], s76 offen offset:0 nt
    v_mov_b32 v46, 0
    v_dot2c_f32_bf16 v46, v208, v6
    v_dot2c_f32_bf16 v46, v209, v7
    v_dot2c_f32_bf16 v46, v210, v8
    v_dot2c_f32_bf16 v46, v211, v9
    v_dot2c_f32_bf16 v46, v212, v10
    v_dot2c_f32_bf16 v46, v213, v11
    v_dot2c_f32_bf16 v46, v214, v12
    v_dot2c_f32_bf16 v46, v215, v13
    s_nop 2
    v_add_f32_dpp v48, v46, v46 row_ror:8 row_mask:0xf bank_mask:0x3
    v_mov_b32 v47, 0
    v_dot2c_f32_bf16 v47, v216, v6
    v_dot2c_f32_bf16 v47, v217, v7
    v_dot2c_f32_bf16 v47, v218, v8
    v_dot2c_f32_bf16 v47, v219, v9
    v_dot2c_f32_bf16 v47, v220, v10
    v_dot2c_f32_bf16 v47, v221, v11
    v_dot2c_f32_bf16 v47, v222, v12
    v_dot2c_f32_bf16 v47, v223, v13
    s_nop 2
    v_add_f32_dpp v48, v47, v47 row_ror:8 row_mask:0xf bank_mask:0xc
    s_nop 1
    v_add_f32_dpp v50, v48, v48 row_half_mirror row_mask:0xf bank_mask:0xa
    v_mov_b32_dpp v52, v30 quad_perm:[1,2,3,0] row_mask:0xf bank_mask:0xf
    s_nop 0
    v_add_f32_dpp v50, v50, v50 quad_perm:[2,3,0,1] row_mask:0xf bank_mask:0xf
    s_nop 1
    v_add_f32_dpp v50, v50, v50 quad_perm:[1,0,3,2] row_mask:0xf bank_mask:0xf
    v_cndmask_b32 v30, v52, v50, s[98:99]
    v_mov_b32 v46, 0
    v_dot2c_f32_bf16 v46, v224, v6
    v_dot2c_f32_bf16 v46, v225, v7
    v_dot2c_f32_bf16 v46, v226, v8
    v_dot2c_f32_bf16 v46, v227, v9
    v_dot2c_f32_bf16 v46, v228, v10
    v_dot2c_f32_bf16 v46, v229, v11
    v_dot2c_f32_bf16 v46, v230, v12
    v_dot2c_f32_bf16 v46, v231, v13
    s_nop 2
    v_add_f32_dpp v48, v46, v46 row_ror:8 row_mask:0xf bank_mask:0x3
    s_waitcnt vmcnt(4)
    buffer_load_dwordx4 v[92:95], v1, s[32:35], s76 offen offset:256 nt
    s_add_u32 s76, s76, 106496
    s_bitset0_b32 s76, 21
    v_mov_b32 v47, 0
    v_dot2c_f32_bf16 v47, v232, v6
    v_dot2c_f32_bf16 v47, v233, v7
    v_dot2c_f32_bf16 v47, v234, v8
    v_dot2c_f32_bf16 v47, v235, v9
    v_dot2c_f32_bf16 v47, v236, v10
    v_dot2c_f32_bf16 v47, v237, v11
    v_dot2c_f32_bf16 v47, v238, v12
    v_dot2c_f32_bf16 v47, v239, v13
    s_nop 2
    v_add_f32_dpp v48, v47, v47 row_ror:8 row_mask:0xf bank_mask:0xc
    s_nop 1
    v_add_f32_dpp v50, v48, v48 row_half_mirror row_mask:0xf bank_mask:0x5
    ds_read_b128 v[192:195], v57 offset:256
    v_mov_b32 v46, 0
    v_dot2c_f32_bf16 v46, v240, v6
    v_dot2c_f32_bf16 v46, v241, v7
    v_dot2c_f32_bf16 v46, v242, v8
    v_dot2c_f32_bf16 v46, v243, v9
    ds_read_b128 v[196:199], v57 offset:1280
    v_dot2c_f32_bf16 v46, v244, v10
    v_dot2c_f32_bf16 v46, v245, v11
    v_dot2c_f32_bf16 v46, v246, v12
    v_dot2c_f32_bf16 v46, v247, v13
    s_nop 2
    v_add_f32_dpp v48, v46, v46 row_ror:8 row_mask:0xf bank_mask:0x3
    ds_read_b128 v[200:203], v57 offset:2304
    v_mov_b32 v47, 0
    v_dot2c_f32_bf16 v47, v248, v6
    v_dot2c_f32_bf16 v47, v249, v7
    v_dot2c_f32_bf16 v47, v250, v8
    v_dot2c_f32_bf16 v47, v251, v9
    ds_read_b128 v[204:207], v57 offset:3328
    v_dot2c_f32_bf16 v47, v252, v10
    v_dot2c_f32_bf16 v47, v253, v11
    v_dot2c_f32_bf16 v47, v254, v12
    v_dot2c_f32_bf16 v47, v255, v13
    s_nop 2
    v_add_f32_dpp v48, v47, v47 row_ror:8 row_mask:0xf bank_mask:0xc
    s_nop 1
    v_add_f32_dpp v50, v48, v48 row_half_mirror row_mask:0xf bank_mask:0xa
    v_mov_b32_dpp v52, v31 quad_perm:[1,2,3,0] row_mask:0xf bank_mask:0xf
    s_nop 0
    v_add_f32_dpp v50, v50, v50 quad_perm:[2,3,0,1] row_mask:0xf bank_mask:0xf
    s_nop 1
    v_add_f32_dpp v50, v50, v50 quad_perm:[1,0,3,2] row_mask:0xf bank_mask:0xf
    v_cndmask_b32 v31, v52, v50, s[98:99]
    s_waitcnt vmcnt(4)
    buffer_load_dwordx4 v[96:99], v1, s[32:35], s76 offen offset:0 nt
    ds_read_b128 v[208:211], v57 offset:4352
    s_waitcnt lgkmcnt(4)
    v_mov_b32 v46, 0
    v_dot2c_f32_bf16 v46, v192, v6
    v_dot2c_f32_bf16 v46, v193, v7
    v_dot2c_f32_bf16 v46, v194, v8
    v_dot2c_f32_bf16 v46, v195, v9
    ds_read_b128 v[212:215], v57 offset:5376
    s_waitcnt lgkmcnt(4)
    v_dot2c_f32_bf16 v46, v196, v10
    v_dot2c_f32_bf16 v46, v197, v11
    v_dot2c_f32_bf16 v46, v198, v12
    v_dot2c_f32_bf16 v46, v199, v13
    s_nop 2
    v_add_f32_dpp v48, v46, v46 row_ror:8 row_mask:0xf bank_mask:0x3
    ds_read_b128 v[216:219], v57 offset:6400
    s_waitcnt lgkmcnt(4)
    v_mov_b32 v47, 0
    v_dot2c_f32_bf16 v47, v200, v6
    v_dot2c_f32_bf16 v47, v201, v7
    v_dot2c_f32_bf16 v47, v202, v8
    v_dot2c_f32_bf16 v47, v203, v9
    ds_read_b128 v[220:223], v57 offset:7424
    s_waitcnt lgkmcnt(4)
    v_dot2c_f32_bf16 v47, v204, v10
    v_dot2c_f32_bf16 v47, v205, v11
    v_dot2c_f32_bf16 v47, v206, v12
    v_dot2c_f32_bf16 v47, v207, v13
    s_nop 2
    v_add_f32_dpp v48, v47, v47 row_ror:8 row_mask:0xf bank_mask:0xc
    s_nop 1
    v_add_f32_dpp v50, v48, v48 row_half_mirror row_mask:0xf bank_mask:0x5
    ds_read_b128 v[192:195], v57 offset:8448
    s_waitcnt lgkmcnt(4)
    v_mov_b32 v46, 0
    v_dot2c_f32_bf16 v46, v208, v6
    v_dot2c_f32_bf16 v46, v209, v7
    v_dot2c_f32_bf16 v46, v210, v8
    v_dot2c_f32_bf16 v46, v211, v9
    ds_read_b128 v[196:199], v57 offset:9472
    s_waitcnt lgkmcnt(4)
    v_dot2c_f32_bf16 v46, v212, v10
    v_dot2c_f32_bf16 v46, v213, v11
    v_dot2c_f32_bf16 v46, v214, v12
    v_dot2c_f32_bf16 v46, v215, v13
    s_nop 2
    v_add_f32_dpp v48, v46, v46 row_ror:8 row_mask:0xf bank_mask:0x3
    s_waitcnt vmcnt(4)
    buffer_load_dwordx4 v[100:103], v1, s[32:35], s76 offen offset:256 nt
    s_addk_i32 s76, 8192
    ds_read_b128 v[200:203], v57 offset:10496
    s_waitcnt lgkmcnt(4)
    v_mov_b32 v47, 0
    v_dot2c_f32_bf16 v47, v216, v6
    v_dot2c_f32_bf16 v47, v217, v7
    v_dot2c_f32_bf16 v47, v218, v8
    v_dot2c_f32_bf16 v47, v219, v9
    ds_read_b128 v[204:207], v57 offset:11520
    s_waitcnt lgkmcnt(4)
    v_dot2c_f32_bf16 v47, v220, v10
    v_dot2c_f32_bf16 v47, v221, v11
    v_dot2c_f32_bf16 v47, v222, v12
    v_dot2c_f32_bf16 v47, v223, v13
    s_nop 2
    v_add_f32_dpp v48, v47, v47 row_ror:8 row_mask:0xf bank_mask:0xc
    s_nop 1
    v_add_f32_dpp v50, v48, v48 row_half_mirror row_mask:0xf bank_mask:0xa
    v_mov_b32_dpp v52, v32 quad_perm:[1,2,3,0] row_mask:0xf bank_mask:0xf
    s_nop 0
    v_add_f32_dpp v50, v50, v50 quad_perm:[2,3,0,1] row_mask:0xf bank_mask:0xf
    s_nop 1
    v_add_f32_dpp v50, v50, v50 quad_perm:[1,0,3,2] row_mask:0xf bank_mask:0xf
    v_cndmask_b32 v32, v52, v50, s[98:99]
    s_waitcnt lgkmcnt(3)
    v_mov_b32 v46, 0
    v_dot2c_f32_bf16 v46, v192, v6
    v_dot2c_f32_bf16 v46, v193, v7
    v_dot2c_f32_bf16 v46, v194, v8
    v_dot2c_f32_bf16 v46, v195, v9
    s_waitcnt lgkmcnt(2)
    v_dot2c_f32_bf16 v46, v196, v10
    v_dot2c_f32_bf16 v46, v197, v11
    v_dot2c_f32_bf16 v46, v198, v12
    v_dot2c_f32_bf16 v46, v199, v13
    s_nop 2
    v_add_f32_dpp v48, v46, v46 row_ror:8 row_mask:0xf bank_mask:0x3
    s_waitcnt lgkmcnt(1)
    v_mov_b32 v47, 0
    v_dot2c_f32_bf16 v47, v200, v6
    v_dot2c_f32_bf16 v47, v201, v7
    v_dot2c_f32_bf16 v47, v202, v8
    v_dot2c_f32_bf16 v47, v203, v9
    s_waitcnt vmcnt(4)
    buffer_load_dwordx4 v[104:107], v1, s[32:35], s76 offen offset:0 nt
    s_waitcnt lgkmcnt(0)
    v_dot2c_f32_bf16 v47, v204, v10
    v_dot2c_f32_bf16 v47, v205, v11
    v_dot2c_f32_bf16 v47, v206, v12
    v_dot2c_f32_bf16 v47, v207, v13
    s_nop 2
    v_add_f32_dpp v48, v47, v47 row_ror:8 row_mask:0xf bank_mask:0xc
    s_nop 1
    v_add_f32_dpp v50, v48, v48 row_half_mirror row_mask:0xf bank_mask:0x5
    s_waitcnt vmcnt(4)
    buffer_load_dwordx4 v[108:111], v1, s[32:35], s76 offen offset:256 nt
    s_addk_i32 s76, 8192
    v_mov_b32 v46, 0
    v_dot2c_f32_bf16 v46, v128, v6
    v_dot2c_f32_bf16 v46, v129, v7
    v_dot2c_f32_bf16 v46, v130, v8
    v_dot2c_f32_bf16 v46, v131, v9
    s_waitcnt vmcnt(4)
    buffer_load_dwordx4 v[112:115], v1, s[32:35], s76 offen offset:0 nt
    v_dot2c_f32_bf16 v46, v132, v10
    v_dot2c_f32_bf16 v46, v133, v11
    v_dot2c_f32_bf16 v46, v134, v12
    v_dot2c_f32_bf16 v46, v135, v13
    s_nop 2
    v_add_f32_dpp v48, v46, v46 row_ror:8 row_mask:0xf bank_mask:0x3
    s_waitcnt vmcnt(4)
    buffer_load_dwordx4 v[116:119], v1, s[32:35], s76 offen offset:256 nt
    s_addk_i32 s76, 8192
    v_mov_b32 v47, 0
    v_dot2c_f32_bf16 v47, v136, v6
    v_dot2c_f32_bf16 v47, v137, v7
    v_dot2c_f32_bf16 v47, v138, v8
    v_dot2c_f32_bf16 v47, v139, v9
    s_waitcnt vmcnt(4)
    buffer_load_dwordx4 v[120:123], v1, s[32:35], s76 offen offset:0 nt
    v_dot2c_f32_bf16 v47, v140, v10
    v_dot2c_f32_bf16 v47, v141, v11
    v_dot2c_f32_bf16 v47, v142, v12
    v_dot2c_f32_bf16 v47, v143, v13
    s_nop 2
    v_add_f32_dpp v48, v47, v47 row_ror:8 row_mask:0xf bank_mask:0xc
    s_nop 1
    v_add_f32_dpp v50, v48, v48 row_half_mirror row_mask:0xf bank_mask:0xa
    v_mov_b32_dpp v52, v33 quad_perm:[1,2,3,0] row_mask:0xf bank_mask:0xf
    s_nop 0
    v_add_f32_dpp v50, v50, v50 quad_perm:[2,3,0,1] row_mask:0xf bank_mask:0xf
    s_nop 1
    v_add_f32_dpp v50, v50, v50 quad_perm:[1,0,3,2] row_mask:0xf bank_mask:0xf
    v_cndmask_b32 v33, v52, v50, s[98:99]
    s_waitcnt vmcnt(4)
    buffer_load_dwordx4 v[124:127], v1, s[32:35], s76 offen offset:256 nt
    s_add_u32 s76, s76, 106496
    s_bitset0_b32 s76, 21
    s_lshl2_add_u32 s78, s3, 46608
    v_mov_b32 v59, s78
    v_mov_b32 v58, 0
    s_mov_b32 s94, 4
    s_mov_b32 s77, 4
L_k:
    s_sub_u32 s77, s77, 1
    s_cmp_eq_u32 s77, 0
    s_cselect_b32 s32, s40, s32
    s_cselect_b32 s33, s41, s33
    s_cselect_b32 s34, s42, s34
    s_cselect_b32 s76, s95, s76
    s_cselect_b32 s70, 409599, s70
    s_cselect_b32 s100, 114688, s100
    s_waitcnt vmcnt(14)
    v_mov_b32 v46, 0
    v_dot2c_f32_bf16 v46, v64, v6
    v_dot2c_f32_bf16 v46, v65, v7
    v_dot2c_f32_bf16 v46, v66, v8
    v_dot2c_f32_bf16 v46, v67, v9
    v_dot2c_f32_bf16 v46, v68, v10
    v_dot2c_f32_bf16 v46, v69, v11
    v_dot2c_f32_bf16 v46, v70, v12
    v_dot2c_f32_bf16 v46, v71, v13
    s_nop 2
    v_add_f32_dpp v48, v46, v46 row_ror:8 row_mask:0xf bank_mask:0x3
    s_cmp_le_u32 s94, 5
    s_cbranch_scc1 L_low1
    s_waitcnt vmcnt(12)
    s_cmp_gt_u32 s94, 10
    s_cbranch_scc1 L_lad1
    s_waitcnt vmcnt(10)
    s_cmp_gt_u32 s94, 8
    s_cbranch_scc1 L_lad1
    s_waitcnt vmcnt(8)
    s_cmp_gt_u32 s94, 7
    s_cbranch_scc1 L_lad1
    s_waitcnt vmcnt(7)
    s_cmp_gt_u32 s94, 6
    s_cbranch_scc1 L_lad1
    s_waitcnt vmcnt(6)
    s_cmp_gt_u32 s94, 5
    s_cbranch_scc1 L_lad1
L_low1:
    s_waitcnt vmcnt(5)
    s_cmp_gt_u32 s94, 4
    s_cbranch_scc1 L_lad1
    s_waitcnt vmcnt(4)
    s_cmp_gt_u32 s94, 3
    s_cbranch_scc1 L_lad1
    s_waitcnt vmcnt(3)
L_lad1:
    buffer_load_dwordx4 v[64:67], v1, s[32:35], s76 offen offset:0 nt
    buffer_load_dwordx4 v[68:71], v1, s[32:35], s76 offen offset:256 nt
    s_or_b32 s76, s76, s100
    s_addk_i32 s76, 8192
    s_and_b32 s76, s76, s70
    v_add_u32 v58, 1, v58
    ds_write_b32 v59, v58
    ds_read_b32 v62, v59 offset:16
    s_waitcnt vmcnt(14) lgkmcnt(0)
    v_readfirstlane_b32 s94, v62
    v_mov_b32 v47, 0
    v_dot2c_f32_bf16 v47, v72, v6
    v_dot2c_f32_bf16 v47, v73, v7
    v_dot2c_f32_bf16 v47, v74, v8
    v_dot2c_f32_bf16 v47, v75, v9
    v_dot2c_f32_bf16 v47, v76, v10
    v_dot2c_f32_bf16 v47, v77, v11
    v_dot2c_f32_bf16 v47, v78, v12
    v_dot2c_f32_bf16 v47, v79, v13
    s_nop 2
    v_add_f32_dpp v48, v47, v47 row_ror:8 row_mask:0xf bank_mask:0xc
    s_nop 1
    v_add_f32_dpp v50, v48, v48 row_half_mirror row_mask:0xf bank_mask:0x5
    s_cmp_le_u32 s94, 5
    s_cbranch_scc1 L_low2
    s_waitcnt vmcnt(12)
    s_cmp_gt_u32 s94, 10
    s_cbranch_scc1 L_lad2
    s_waitcnt vmcnt(10)
    s_cmp_gt_u32 s94, 8
    s_cbranch_scc1 L_lad2
    s_waitcnt vmcnt(8)
    s_cmp_gt_u32 s94, 7
    s_cbranch_scc1 L_lad2
    s_waitcnt vmcnt(7)
    s_cmp_gt_u32 s94, 6
    s_cbranch_scc1 L_lad2
    s_waitcnt vmcnt(6)
    s_cmp_gt_u32 s94, 5
    s_cbranch_scc1 L_lad2
L_low2:
    s_waitcnt vmcnt(5)
    s_cmp_gt_u32 s94, 4
    s_cbranch_scc1 L_lad2
    s_waitcnt vmcnt(4)
    s_cmp_gt_u32 s94, 3
    s_cbranch_scc1 L_lad2
    s_waitcnt vmcnt(3)
L_lad2:
    buffer_load_dwordx4 v[72:75], v1, s[32:35], s76 offen offset:0 nt
    buffer_load_dwordx4 v[76:79], v1, s[32:35], s76 offen offset:256 nt
    s_or_b32 s76, s76, s100
    s_addk_i32 s76, 8192
    s_and_b32 s76, s76, s70
    v_add_u32 v58, 1, v58
    ds_write_b32 v59, v58
    s_waitcnt vmcnt(14)
    v_mov_b32 v46, 0
    v_dot2c_f32_bf16 v46, v80, v6
    v_dot2c_f32_bf16 v46, v81, v7
    v_dot2c_f32_bf16 v46, v82, v8
    v_dot2c_f32_bf16 v46, v83, v9
    v_dot2c_f32_bf16 v46, v84, v10
    v_dot2c_f32_bf16 v46, v85, v11
    v_dot2c_f32_bf16 v46, v86, v12
    v_dot2c_f32_bf16 v46, v87, v13
    s_nop 2
    v_add_f32_dpp v48, v46, v46 row_ror:8 row_mask:0xf bank_mask:0x3
    s_cmp_le_u32 s94, 5
    s_cbranch_scc1 L_low3
    s_waitcnt vmcnt(12)
    s_cmp_gt_u32 s94, 10
    s_cbranch_scc1 L_lad3
    s_waitcnt vmcnt(10)
    s_cmp_gt_u32 s94, 8
    s_cbranch_scc1 L_lad3
    s_waitcnt vmcnt(8)
    s_cmp_gt_u32 s94, 7
    s_cbranch_scc1 L_lad3
    s_waitcnt vmcnt(7)
    s_cmp_gt_u32 s94, 6
    s_cbranch_scc1 L_lad3
    s_waitcnt vmcnt(6)
    s_cmp_gt_u32 s94, 5
    s_cbranch_scc1 L_lad3
L_low3:
    s_waitcnt vmcnt(5)
    s_cmp_gt_u32 s94, 4
    s_cbranch_scc1 L_lad3
    s_waitcnt vmcnt(4)
    s_cmp_gt_u32 s94, 3
    s_cbranch_scc1 L_lad3
    s_waitcnt vmcnt(3)
L_lad3:
    buffer_load_dwordx4 v[80:83], v1, s[32:35], s76 offen offset:0 nt
    buffer_load_dwordx4 v[84:87], v1, s[32:35], s76 offen offset:256 nt
    s_or_b32 s76, s76, s100
    s_addk_i32 s76, 8192
    s_and_b32 s76, s76, s70
    v_add_u32 v58, 1, v58
    ds_write_b32 v59, v58
    ds_read_b32 v62, v59 offset:16
    s_waitcnt vmcnt(14) lgkmcnt(0)
    v_readfirstlane_b32 s94, v62
    v_mov_b32 v47, 0
    v_dot2c_f32_bf16 v47, v88, v6
    v_dot2c_f32_bf16 v47, v89, v7
    v_dot2c_f32_bf16 v47, v90, v8
    v_dot2c_f32_bf16 v47, v91, v9
    v_dot2c_f32_bf16 v47, v92, v10
    v_dot2c_f32_bf16 v47, v93, v11
    v_dot2c_f32_bf16 v47, v94, v12
    v_dot2c_f32_bf16 v47, v95, v13
    s_nop 2
    v_add_f32_dpp v48, v47, v47 row_ror:8 row_mask:0xf bank_mask:0xc
    s_nop 1
    v_add_f32_dpp v50, v48, v48 row_half_mirror row_mask:0xf bank_mask:0xa
    v_mov_b32_dpp v52, v30 quad_perm:[1,2,3,0] row_mask:0xf bank_mask:0xf
    s_nop 0
    v_add_f32_dpp v50, v50, v50 quad_perm:[2,3,0,1] row_mask:0xf bank_mask:0xf
    v_mov_b32 v30, v31
    v_mov_b32 v31, v32
    v_mov_b32 v32, v33
    v_add_f32_dpp v50, v50, v50 quad_perm:[1,0,3,2] row_mask:0xf bank_mask:0xf
    v_cndmask_b32 v33, v52, v50, s[98:99]
    s_cmp_le_u32 s94, 5
    s_cbranch_scc1 L_low4
    s_waitcnt vmcnt(12)
    s_cmp_gt_u32 s94, 10
    s_cbranch_scc1 L_lad4
    s_waitcnt vmcnt(10)
    s_cmp_gt_u32 s94, 8
    s_cbranch_scc1 L_lad4
    s_waitcnt vmcnt(8)
    s_cmp_gt_u32 s94, 7
    s_cbranch_scc1 L_lad4
    s_waitcnt vmcnt(7)
    s_cmp_gt_u32 s94, 6
    s_cbranch_scc1 L_lad4
    s_waitcnt vmcnt(6)
    s_cmp_gt_u32 s94, 5
    s_cbranch_scc1 L_lad4
L_low4:
    s_waitcnt vmcnt(5)
    s_cmp_gt_u32 s94, 4
    s_cbranch_scc1 L_lad4
    s_waitcnt vmcnt(4)
    s_cmp_gt_u32 s94, 3
    s_cbranch_scc1 L_lad4
    s_waitcnt vmcnt(3)
L_lad4:
    buffer_load_dwordx4 v[88:91], v1, s[32:35], s76 offen offset:0 nt
    buffer_load_dwordx4 v[92:95], v1, s[32:35], s76 offen offset:256 nt
    s_or_b32 s76, s76, s100
    s_addk_i32 s76, 8192
    s_and_b32 s76, s76, s70
    v_add_u32 v58, 1, v58
    ds_write_b32 v59, v58
    s_waitcnt vmcnt(14)
    v_mov_b32 v46, 0
    v_dot2c_f32_bf16 v46, v96, v6
    v_dot2c_f32_bf16 v46, v97, v7
    v_dot2c_f32_bf16 v46, v98, v8
    v_dot2c_f32_bf16 v46, v99, v9
    v_dot2c_f32_bf16 v46, v100, v10
    v_dot2c_f32_bf16 v46, v101, v11
    v_dot2c_f32_bf16 v46, v102, v12
    v_dot2c_f32_bf16 v46, v103, v13
    s_nop 2
    v_add_f32_dpp v48, v46, v46 row_ror:8 row_mask:0xf bank_mask:0x3
    s_cmp_le_u32 s94, 5
    s_cbranch_scc1 L_low5
    s_waitcnt vmcnt(12)
    s_cmp_gt_u32 s94, 10
    s_cbranch_scc1 L_lad5
    s_waitcnt vmcnt(10)
    s_cmp_gt_u32 s94, 8
    s_cbranch_scc1 L_lad5
    s_waitcnt vmcnt(8)
    s_cmp_gt_u32 s94, 7
    s_cbranch_scc1 L_lad5
    s_waitcnt vmcnt(7)
    s_cmp_gt_u32 s94, 6
    s_cbranch_scc1 L_lad5
    s_waitcnt vmcnt(6)
    s_cmp_gt_u32 s94, 5
    s_cbranch_scc1 L_lad5
L_low5:
    s_waitcnt vmcnt(5)
    s_cmp_gt_u32 s94, 4
    s_cbranch_scc1 L_lad5
    s_waitcnt vmcnt(4)
    s_cmp_gt_u32 s94, 3
    s_cbranch_scc1 L_lad5
    s_waitcnt vmcnt(3)
L_lad5:
    buffer_load_dwordx4 v[96:99], v1, s[32:35], s76 offen offset:0 nt
    buffer_load_dwordx4 v[100:103], v1, s[32:35], s76 offen offset:256 nt
    s_or_b32 s76, s76, s100
    s_addk_i32 s76, 8192
    s_and_b32 s76, s76, s70
    v_add_u32 v58, 1, v58
    ds_write_b32 v59, v58
    ds_read_b32 v62, v59 offset:16
    s_waitcnt vmcnt(14) lgkmcnt(0)
    v_readfirstlane_b32 s94, v62
    v_mov_b32 v47, 0
    v_dot2c_f32_bf16 v47, v104, v6
    v_dot2c_f32_bf16 v47, v105, v7
    v_dot2c_f32_bf16 v47, v106, v8
    v_dot2c_f32_bf16 v47, v107, v9
    v_dot2c_f32_bf16 v47, v108, v10
    v_dot2c_f32_bf16 v47, v109, v11
    v_dot2c_f32_bf16 v47, v110, v12
    v_dot2c_f32_bf16 v47, v111, v13
    s_nop 2
    v_add_f32_dpp v48, v47, v47 row_ror:8 row_mask:0xf bank_mask:0xc
    s_nop 1
    v_add_f32_dpp v50, v48, v48 row_half_mirror row_mask:0xf bank_mask:0x5
    s_cmp_le_u32 s94, 5
    s_cbranch_scc1 L_low6
    s_waitcnt vmcnt(12)
    s_cmp_gt_u32 s94, 10
    s_cbranch_scc1 L_lad6
    s_waitcnt vmcnt(10)
    s_cmp_gt_u32 s94, 8
    s_cbranch_scc1 L_lad6
    s_waitcnt vmcnt(8)
    s_cmp_gt_u32 s94, 7
    s_cbranch_scc1 L_lad6
    s_waitcnt vmcnt(7)
    s_cmp_gt_u32 s94, 6
    s_cbranch_scc1 L_lad6
    s_waitcnt vmcnt(6)
    s_cmp_gt_u32 s94, 5
    s_cbranch_scc1 L_lad6
L_low6:
    s_waitcnt vmcnt(5)
    s_cmp_gt_u32 s94, 4
    s_cbranch_scc1 L_lad6
    s_waitcnt vmcnt(4)
    s_cmp_gt_u32 s94, 3
    s_cbranch_scc1 L_lad6
    s_waitcnt vmcnt(3)
L_lad6:
    buffer_load_dwordx4 v[104:107], v1, s[32:35], s76 offen offset:0 nt
    buffer_load_dwordx4 v[108:111], v1, s[32:35], s76 offen offset:256 nt
    s_or_b32 s76, s76, s100
    s_addk_i32 s76, 8192
    s_and_b32 s76, s76, s70
    v_add_u32 v58, 1, v58
    ds_write_b32 v59, v58
    s_waitcnt vmcnt(14)
    v_mov_b32 v46, 0
    v_dot2c_f32_bf16 v46, v112, v6
    v_dot2c_f32_bf16 v46, v113, v7
    v_dot2c_f32_bf16 v46, v114, v8
    v_dot2c_f32_bf16 v46, v115, v9
    v_dot2c_f32_bf16 v46, v116, v10
    v_dot2c_f32_bf16 v46, v117, v11
    v_dot2c_f32_bf16 v46, v118, v12
    v_dot2c_f32_bf16 v46, v119, v13
    s_nop 2
    v_add_f32_dpp v48, v46, v46 row_ror:8 row_mask:0xf bank_mask:0x3
    s_cmp_le_u32 s94, 5
    s_cbranch_scc1 L_low7
    s_waitcnt vmcnt(12)
    s_cmp_gt_u32 s94, 10
    s_cbranch_scc1 L_lad7
    s_waitcnt vmcnt(10)
    s_cmp_gt_u32 s94, 8
    s_cbranch_scc1 L_lad7
    s_waitcnt vmcnt(8)
    s_cmp_gt_u32 s94, 7
    s_cbranch_scc1 L_lad7
    s_waitcnt vmcnt(7)
    s_cmp_gt_u32 s94, 6
    s_cbranch_scc1 L_lad7
    s_waitcnt vmcnt(6)
    s_cmp_gt_u32 s94, 5
    s_cbranch_scc1 L_lad7
L_low7:
    s_waitcnt vmcnt(5)
    s_cmp_gt_u32 s94, 4
    s_cbranch_scc1 L_lad7
    s_waitcnt vmcnt(4)
    s_cmp_gt_u32 s94, 3
    s_cbranch_scc1 L_lad7
    s_waitcnt vmcnt(3)
L_lad7:
    buffer_load_dwordx4 v[112:115], v1, s[32:35], s76 offen offset:0 nt
    buffer_load_dwordx4 v[116:119], v1, s[32:35], s76 offen offset:256 nt
    s_or_b32 s76, s76, s100
    s_addk_i32 s76, 8192
    s_and_b32 s76, s76, s70
    v_add_u32 v58, 1, v58
    ds_write_b32 v59, v58
    ds_read_b32 v62, v59 offset:16
    s_waitcnt vmcnt(14) lgkmcnt(0)
    v_readfirstlane_b32 s94, v62
    v_mov_b32 v47, 0
    v_dot2c_f32_bf16 v47, v120, v6
    v_dot2c_f32_bf16 v47, v121, v7
    v_dot2c_f32_bf16 v47, v122, v8
    v_dot2c_f32_bf16 v47, v123, v9
    v_dot2c_f32_bf16 v47, v124, v10
    v_dot2c_f32_bf16 v47, v125, v11
    v_dot2c_f32_bf16 v47, v126, v12
    v_dot2c_f32_bf16 v47, v127, v13
    s_nop 2
    v_add_f32_dpp v48, v47, v47 row_ror:8 row_mask:0xf bank_mask:0xc
    s_nop 1
    v_add_f32_dpp v50, v48, v48 row_half_mirror row_mask:0xf bank_mask:0xa
    v_mov_b32_dpp v52, v30 quad_perm:[1,2,3,0] row_mask:0xf bank_mask:0xf
    s_nop 0
    v_add_f32_dpp v50, v50, v50 quad_perm:[2,3,0,1] row_mask:0xf bank_mask:0xf
    v_mov_b32 v30, v31
    v_mov_b32 v31, v32
    v_mov_b32 v32, v33
    v_add_f32_dpp v50, v50, v50 quad_perm:[1,0,3,2] row_mask:0xf bank_mask:0xf
    v_cndmask_b32 v33, v52, v50, s[98:99]
    s_cmp_le_u32 s94, 5
    s_cbranch_scc1 L_low8
    s_waitcnt vmcnt(12)
    s_cmp_gt_u32 s94, 10
    s_cbranch_scc1 L_lad8
    s_waitcnt vmcnt(10)
    s_cmp_gt_u32 s94, 8
    s_cbranch_scc1 L_lad8
    s_waitcnt vmcnt(8)
    s_cmp_gt_u32 s94, 7
    s_cbranch_scc1 L_lad8
    s_waitcnt vmcnt(7)
    s_cmp_gt_u32 s94, 6
    s_cbranch_scc1 L_lad8
    s_waitcnt vmcnt(6)
    s_cmp_gt_u32 s94, 5
    s_cbranch_scc1 L_lad8
L_low8:
    s_waitcnt vmcnt(5)
    s_cmp_gt_u32 s94, 4
    s_cbranch_scc1 L_lad8
    s_waitcnt vmcnt(4)
    s_cmp_gt_u32 s94, 3
    s_cbranch_scc1 L_lad8
    s_waitcnt vmcnt(3)
L_lad8:
    buffer_load_dwordx4 v[120:123], v1, s[32:35], s76 offen offset:0 nt
    buffer_load_dwordx4 v[124:127], v1, s[32:35], s76 offen offset:256 nt
    s_or_b32 s76, s76, s100
    s_addk_i32 s76, 8192
    s_and_b32 s76, s76, s70
    v_add_u32 v58, 1, v58
    ds_write_b32 v59, v58
    s_cmp_lg_u32 s77, 0
    s_cbranch_scc1 L_k
    s_waitcnt vmcnt(14)
    v_mov_b32 v46, 0
    v_dot2c_f32_bf16 v46, v64, v14
    v_dot2c_f32_bf16 v46, v65, v15
    v_dot2c_f32_bf16 v46, v66, v16
    v_dot2c_f32_bf16 v46, v67, v17
    v_mov_b32 v47, 0
    v_dot2c_f32_bf16 v47, v64, v22
    v_dot2c_f32_bf16 v47, v65, v23
    v_dot2c_f32_bf16 v47, v66, v24
    v_dot2c_f32_bf16 v47, v67, v25
    v_dot2c_f32_bf16 v46, v68, v18
    v_dot2c_f32_bf16 v46, v69, v19
    v_dot2c_f32_bf16 v46, v70, v20
    v_dot2c_f32_bf16 v46, v71, v21
    v_dot2c_f32_bf16 v47, v68, v26
    v_dot2c_f32_bf16 v47, v69, v27
    v_dot2c_f32_bf16 v47, v70, v28
    v_dot2c_f32_bf16 v47, v71, v29
    v_add_f32_dpp v48, v46, v46 row_ror:8 row_mask:0xf bank_mask:0x3
    s_nop 1
    v_add_f32_dpp v48, v47, v47 row_ror:8 row_mask:0xf bank_mask:0xc
    s_nop 1
    v_add_f32_dpp v50, v48, v48 row_half_mirror row_mask:0xf bank_mask:0x5
    s_cmp_le_u32 s94, 5
    s_cbranch_scc1 L_low9
    s_waitcnt vmcnt(12)
    s_cmp_gt_u32 s94, 10
    s_cbranch_scc1 L_lad9
    s_waitcnt vmcnt(10)
    s_cmp_gt_u32 s94, 8
    s_cbranch_scc1 L_lad9
    s_waitcnt vmcnt(8)
    s_cmp_gt_u32 s94, 7
    s_cbranch_scc1 L_lad9
    s_waitcnt vmcnt(7)
    s_cmp_gt_u32 s94, 6
    s_cbranch_scc1 L_lad9
    s_waitcnt vmcnt(6)
    s_cmp_gt_u32 s94, 5
    s_cbranch_scc1 L_lad9
L_low9:
    s_waitcnt vmcnt(5)
    s_cmp_gt_u32 s94, 4
    s_cbranch_scc1 L_lad9
    s_waitcnt vmcnt(4)
    s_cmp_gt_u32 s94, 3
    s_cbranch_scc1 L_lad9
    s_waitcnt vmcnt(3)
L_lad9:
    s_mov_b32 s76, s95
    buffer_load_dwordx4 v[64:67], v1, s[44:47], s76 offen offset:0 nt
    buffer_load_dwordx4 v[68:71], v1, s[44:47], s76 offen offset:256 nt
    s_or_b32 s76, s76, s100
    s_addk_i32 s76, 8192
    s_and_b32 s76, s76, s70
    v_add_u32 v58, 1, v58
    ds_write_b32 v59, v58
    ds_read_b32 v62, v59 offset:16
    s_waitcnt vmcnt(14) lgkmcnt(0)
    v_readfirstlane_b32 s94, v62
    v_mov_b32 v46, 0
    v_dot2c_f32_bf16 v46, v72, v14
    v_dot2c_f32_bf16 v46, v73, v15
    v_dot2c_f32_bf16 v46, v74, v16
    v_dot2c_f32_bf16 v46, v75, v17
    v_mov_b32 v47, 0
    v_dot2c_f32_bf16 v47, v72, v22
    v_dot2c_f32_bf16 v47, v73, v23
    v_dot2c_f32_bf16 v47, v74, v24
    v_dot2c_f32_bf16 v47, v75, v25
    v_dot2c_f32_bf16 v46, v76, v18
    v_dot2c_f32_bf16 v46, v77, v19
    v_dot2c_f32_bf16 v46, v78, v20
    v_dot2c_f32_bf16 v46, v79, v21
    v_dot2c_f32_bf16 v47, v76, v26
    v_dot2c_f32_bf16 v47, v77, v27
    v_dot2c_f32_bf16 v47, v78, v28
    v_dot2c_f32_bf16 v47, v79, v29
    v_add_f32_dpp v49, v46, v46 row_ror:8 row_mask:0xf bank_mask:0x3
    s_nop 1
    v_add_f32_dpp v49, v47, v47 row_ror:8 row_mask:0xf bank_mask:0xc
    s_nop 1
    v_add_f32_dpp v50, v49, v49 row_half_mirror row_mask:0xf bank_mask:0xa
    s_nop 1
    v_add_f32_dpp v50, v50, v50 quad_perm:[2,3,0,1] row_mask:0xf bank_mask:0xf
    s_cmp_le_u32 s94, 5
    s_cbranch_scc1 L_low10
    s_waitcnt vmcnt(12)
    s_cmp_gt_u32 s94, 10
    s_cbranch_scc1 L_lad10
    s_waitcnt vmcnt(10)
    s_cmp_gt_u32 s94, 8
    s_cbranch_scc1 L_lad10
    s_waitcnt vmcnt(8)
    s_cmp_gt_u32 s94, 7
    s_cbranch_scc1 L_lad10
    s_waitcnt vmcnt(7)
    s_cmp_gt_u32 s94, 6
    s_cbranch_scc1 L_lad10
    s_waitcnt vmcnt(6)
    s_cmp_gt_u32 s94, 5
    s_cbranch_scc1 L_lad10
L_low10:
    s_waitcnt vmcnt(5)
    s_cmp_gt_u32 s94, 4
    s_cbranch_scc1 L_lad10
    s_waitcnt vmcnt(4)
    s_cmp_gt_u32 s94, 3
    s_cbranch_scc1 L_lad10
    s_waitcnt vmcnt(3)
L_lad10:
    buffer_load_dwordx4 v[72:75], v1, s[44:47], s76 offen offset:0 nt
    buffer_load_dwordx4 v[76:79], v1, s[44:47], s76 offen offset:256 nt
    s_or_b32 s76, s76, s100
    s_addk_i32 s76, 8192
    s_and_b32 s76, s76, s70
    v_add_u32 v58, 1, v58
    ds_write_b32 v59, v58
    s_waitcnt vmcnt(14)
    v_mov_b32 v46, 0
    v_dot2c_f32_bf16 v46, v80, v14
    v_dot2c_f32_bf16 v46, v81, v15
    v_dot2c_f32_bf16 v46, v82, v16
    v_dot2c_f32_bf16 v46, v83, v17
    v_mov_b32 v47, 0
    v_dot2c_f32_bf16 v47, v80, v22
    v_dot2c_f32_bf16 v47, v81, v23
    v_dot2c_f32_bf16 v47, v82, v24
    v_dot2c_f32_bf16 v47, v83, v25
    v_dot2c_f32_bf16 v46, v84, v18
    v_dot2c_f32_bf16 v46, v85, v19
    v_dot2c_f32_bf16 v46, v86, v20
    v_dot2c_f32_bf16 v46, v87, v21
    v_dot2c_f32_bf16 v47, v84, v26
    v_dot2c_f32_bf16 v47, v85, v27
    v_dot2c_f32_bf16 v47, v86, v28
    v_dot2c_f32_bf16 v47, v87, v29
    v_add_f32_dpp v48, v46, v46 row_ror:8 row_mask:0xf bank_mask:0x3
    s_nop 1
    v_add_f32_dpp v48, v47, v47 row_ror:8 row_mask:0xf bank_mask:0xc
    s_nop 1
    v_add_f32_dpp v51, v48, v48 row_half_mirror row_mask:0xf bank_mask:0x5
    s_cmp_le_u32 s94, 5
    s_cbranch_scc1 L_low11
    s_waitcnt vmcnt(12)
    s_cmp_gt_u32 s94, 10
    s_cbranch_scc1 L_lad11
    s_waitcnt vmcnt(10)
    s_cmp_gt_u32 s94, 8
    s_cbranch_scc1 L_lad11
    s_waitcnt vmcnt(8)
    s_cmp_gt_u32 s94, 7
    s_cbranch_scc1 L_lad11
    s_waitcnt vmcnt(7)
    s_cmp_gt_u32 s94, 6
    s_cbranch_scc1 L_lad11
    s_waitcnt vmcnt(6)
    s_cmp_gt_u32 s94, 5
    s_cbranch_scc1 L_lad11
L_low11:
    s_waitcnt vmcnt(5)
    s_cmp_gt_u32 s94, 4
    s_cbranch_scc1 L_lad11
    s_waitcnt vmcnt(4)
    s_cmp_gt_u32 s94, 3
    s_cbranch_scc1 L_lad11
    s_waitcnt vmcnt(3)
L_lad11:
    buffer_load_dwordx4 v[80:83], v1, s[44:47], s76 offen offset:0 nt
    buffer_load_dwordx4 v[84:87], v1, s[44:47], s76 offen offset:256 nt
    s_or_b32 s76, s76, s100
    s_addk_i32 s76, 8192
    s_and_b32 s76, s76, s70
    v_add_u32 v58, 1, v58
    ds_write_b32 v59, v58
    ds_read_b32 v62, v59 offset:16
    s_waitcnt vmcnt(14) lgkmcnt(0)
    v_readfirstlane_b32 s94, v62
    v_mov_b32 v46, 0
    v_dot2c_f32_bf16 v46, v88, v14
    v_dot2c_f32_bf16 v46, v89, v15
    v_dot2c_f32_bf16 v46, v90, v16
    v_dot2c_f32_bf16 v46, v91, v17
    v_mov_b32 v47, 0
    v_dot2c_f32_bf16 v47, v88, v22
    v_dot2c_f32_bf16 v47, v89, v23
    v_dot2c_f32_bf16 v47, v90, v24
    v_dot2c_f32_bf16 v47, v91, v25
    v_dot2c_f32_bf16 v46, v92, v18
    v_dot2c_f32_bf16 v46, v93, v19
    v_dot2c_f32_bf16 v46, v94, v20
    v_dot2c_f32_bf16 v46, v95, v21
    v_dot2c_f32_bf16 v47, v92, v26
    v_dot2c_f32_bf16 v47, v93, v27
    v_dot2c_f32_bf16 v47, v94, v28
    v_dot2c_f32_bf16 v47, v95, v29
    v_add_f32_dpp v49, v46, v46 row_ror:8 row_mask:0xf bank_mask:0x3
    s_nop 1
    v_add_f32_dpp v49, v47, v47 row_ror:8 row_mask:0xf bank_mask:0xc
    s_nop 1
    v_add_f32_dpp v51, v49, v49 row_half_mirror row_mask:0xf bank_mask:0xa
    s_nop 1
    v_add_f32_dpp v51, v51, v51 quad_perm:[2,3,0,1] row_mask:0xf bank_mask:0xf
    v_cndmask_b32 v52, v50, v51, s[90:91]
    s_nop 1
    v_add_f32_dpp v52, v52, v52 quad_perm:[1,0,3,2] row_mask:0xf bank_mask:0xf
    s_cmp_le_u32 s94, 5
    s_cbranch_scc1 L_low12
    s_waitcnt vmcnt(12)
    s_cmp_gt_u32 s94, 10
    s_cbranch_scc1 L_lad12
    s_waitcnt vmcnt(10)
    s_cmp_gt_u32 s94, 8
    s_cbranch_scc1 L_lad12
    s_waitcnt vmcnt(8)
    s_cmp_gt_u32 s94, 7
    s_cbranch_scc1 L_lad12
    s_waitcnt vmcnt(7)
    s_cmp_gt_u32 s94, 6
    s_cbranch_scc1 L_lad12
    s_waitcnt vmcnt(6)
    s_cmp_gt_u32 s94, 5
    s_cbranch_scc1 L_lad12
L_low12:
    s_waitcnt vmcnt(5)
    s_cmp_gt_u32 s94, 4
    s_cbranch_scc1 L_lad12
    s_waitcnt vmcnt(4)
    s_cmp_gt_u32 s94, 3
    s_cbranch_scc1 L_lad12
    s_waitcnt vmcnt(3)
L_lad12:
    buffer_load_dwordx4 v[88:91], v1, s[44:47], s76 offen offset:0 nt
    buffer_load_dwordx4 v[92:95], v1, s[44:47], s76 offen offset:256 nt
    s_or_b32 s76, s76, s100
    s_addk_i32 s76, 8192
    s_and_b32 s76, s76, s70
    v_add_u32 v58, 1, v58
    ds_write_b32 v59, v58
    s_waitcnt vmcnt(14)
    v_mov_b32 v46, 0
    v_dot2c_f32_bf16 v46, v96, v14
    v_dot2c_f32_bf16 v46, v97, v15
    v_dot2c_f32_bf16 v46, v98, v16
    v_dot2c_f32_bf16 v46, v99, v17
    v_mov_b32 v47, 0
    v_dot2c_f32_bf16 v47, v96, v22
    v_dot2c_f32_bf16 v47, v97, v23
    v_dot2c_f32_bf16 v47, v98, v24
    v_dot2c_f32_bf16 v47, v99, v25
    v_dot2c_f32_bf16 v46, v100, v18
    v_dot2c_f32_bf16 v46, v101, v19
    v_dot2c_f32_bf16 v46, v102, v20
    v_dot2c_f32_bf16 v46, v103, v21
    v_dot2c_f32_bf16 v47, v100, v26
    v_dot2c_f32_bf16 v47, v101, v27
    v_dot2c_f32_bf16 v47, v102, v28
    v_dot2c_f32_bf16 v47, v103, v29
    v_add_f32_dpp v48, v46, v46 row_ror:8 row_mask:0xf bank_mask:0x3
    s_nop 1
    v_add_f32_dpp v48, v47, v47 row_ror:8 row_mask:0xf bank_mask:0xc
    s_nop 1
    v_add_f32_dpp v50, v48, v48 row_half_mirror row_mask:0xf bank_mask:0x5
    s_cmp_le_u32 s94, 5
    s_cbranch_scc1 L_low13
    s_waitcnt vmcnt(12)
    s_cmp_gt_u32 s94, 10
    s_cbranch_scc1 L_lad13
    s_waitcnt vmcnt(10)
    s_cmp_gt_u32 s94, 8
    s_cbranch_scc1 L_lad13
    s_waitcnt vmcnt(8)
    s_cmp_gt_u32 s94, 7
    s_cbranch_scc1 L_lad13
    s_waitcnt vmcnt(7)
    s_cmp_gt_u32 s94, 6
    s_cbranch_scc1 L_lad13
    s_waitcnt vmcnt(6)
    s_cmp_gt_u32 s94, 5
    s_cbranch_scc1 L_lad13
L_low13:
    s_waitcnt vmcnt(5)
    s_cmp_gt_u32 s94, 4
    s_cbranch_scc1 L_lad13
    s_waitcnt vmcnt(4)
    s_cmp_gt_u32 s94, 3
    s_cbranch_scc1 L_lad13
    s_waitcnt vmcnt(3)
L_lad13:
    buffer_load_dwordx4 v[96:99], v1, s[44:47], s76 offen offset:0 nt
    buffer_load_dwordx4 v[100:103], v1, s[44:47], s76 offen offset:256 nt
    s_or_b32 s76, s76, s100
    s_addk_i32 s76, 8192
    s_and_b32 s76, s76, s70
    v_add_u32 v58, 1, v58
    ds_write_b32 v59, v58
    ds_read_b32 v62, v59 offset:16
    s_waitcnt vmcnt(14) lgkmcnt(0)
    v_readfirstlane_b32 s94, v62
    v_mov_b32 v46, 0
    v_dot2c_f32_bf16 v46, v104, v14
    v_dot2c_f32_bf16 v46, v105, v15
    v_dot2c_f32_bf16 v46, v106, v16
    v_dot2c_f32_bf16 v46, v107, v17
    v_mov_b32 v47, 0
    v_dot2c_f32_bf16 v47, v104, v22
    v_dot2c_f32_bf16 v47, v105, v23
    v_dot2c_f32_bf16 v47, v106, v24
    v_dot2c_f32_bf16 v47, v107, v25
    v_dot2c_f32_bf16 v46, v108, v18
    v_dot2c_f32_bf16 v46, v109, v19
    v_dot2c_f32_bf16 v46, v110, v20
    v_dot2c_f32_bf16 v46, v111, v21
    v_dot2c_f32_bf16 v47, v108, v26
    v_dot2c_f32_bf16 v47, v109, v27
    v_dot2c_f32_bf16 v47, v110, v28
    v_dot2c_f32_bf16 v47, v111, v29
    v_add_f32_dpp v49, v46, v46 row_ror:8 row_mask:0xf bank_mask:0x3
    s_nop 1
    v_add_f32_dpp v49, v47, v47 row_ror:8 row_mask:0xf bank_mask:0xc
    s_nop 1
    v_add_f32_dpp v50, v49, v49 row_half_mirror row_mask:0xf bank_mask:0xa
    s_nop 1
    v_add_f32_dpp v50, v50, v50 quad_perm:[2,3,0,1] row_mask:0xf bank_mask:0xf
    s_cmp_le_u32 s94, 5
    s_cbranch_scc1 L_low14
    s_waitcnt vmcnt(12)
    s_cmp_gt_u32 s94, 10
    s_cbranch_scc1 L_lad14
    s_waitcnt vmcnt(10)
    s_cmp_gt_u32 s94, 8
    s_cbranch_scc1 L_lad14
    s_waitcnt vmcnt(8)
    s_cmp_gt_u32 s94, 7
    s_cbranch_scc1 L_lad14
    s_waitcnt vmcnt(7)
    s_cmp_gt_u32 s94, 6
    s_cbranch_scc1 L_lad14
    s_waitcnt vmcnt(6)
    s_cmp_gt_u32 s94, 5
    s_cbranch_scc1 L_lad14
L_low14:
    s_waitcnt vmcnt(5)
    s_cmp_gt_u32 s94, 4
    s_cbranch_scc1 L_lad14
    s_waitcnt vmcnt(4)
    s_cmp_gt_u32 s94, 3
    s_cbranch_scc1 L_lad14
    s_waitcnt vmcnt(3)
L_lad14:
    buffer_load_dwordx4 v[104:107], v1, s[44:47], s76 offen offset:0 nt
    buffer_load_dwordx4 v[108:111], v1, s[44:47], s76 offen offset:256 nt
    s_or_b32 s76, s76, s100
    s_addk_i32 s76, 8192
    s_and_b32 s76, s76, s70
    v_add_u32 v58, 1, v58
    ds_write_b32 v59, v58
    s_waitcnt vmcnt(14)
    v_mov_b32 v46, 0
    v_dot2c_f32_bf16 v46, v112, v14
    v_dot2c_f32_bf16 v46, v113, v15
    v_dot2c_f32_bf16 v46, v114, v16
    v_dot2c_f32_bf16 v46, v115, v17
    v_mov_b32 v47, 0
    v_dot2c_f32_bf16 v47, v112, v22
    v_dot2c_f32_bf16 v47, v113, v23
    v_dot2c_f32_bf16 v47, v114, v24
    v_dot2c_f32_bf16 v47, v115, v25
    v_dot2c_f32_bf16 v46, v116, v18
    v_dot2c_f32_bf16 v46, v117, v19
    v_dot2c_f32_bf16 v46, v118, v20
    v_dot2c_f32_bf16 v46, v119, v21
    v_dot2c_f32_bf16 v47, v116, v26
    v_dot2c_f32_bf16 v47, v117, v27
    v_dot2c_f32_bf16 v47, v118, v28
    v_dot2c_f32_bf16 v47, v119, v29
    v_add_f32_dpp v48, v46, v46 row_ror:8 row_mask:0xf bank_mask:0x3
    s_nop 1
    v_add_f32_dpp v48, v47, v47 row_ror:8 row_mask:0xf bank_mask:0xc
    s_nop 1
    v_add_f32_dpp v51, v48, v48 row_half_mirror row_mask:0xf bank_mask:0x5
    s_cmp_le_u32 s94, 5
    s_cbranch_scc1 L_low15
    s_waitcnt vmcnt(12)
    s_cmp_gt_u32 s94, 10
    s_cbranch_scc1 L_lad15
    s_waitcnt vmcnt(10)
    s_cmp_gt_u32 s94, 8
    s_cbranch_scc1 L_lad15
    s_waitcnt vmcnt(8)
    s_cmp_gt_u32 s94, 7
    s_cbranch_scc1 L_lad15
    s_waitcnt vmcnt(7)
    s_cmp_gt_u32 s94, 6
    s_cbranch_scc1 L_lad15
    s_waitcnt vmcnt(6)
    s_cmp_gt_u32 s94, 5
    s_cbranch_scc1 L_lad15
L_low15:
    s_waitcnt vmcnt(5)
    s_cmp_gt_u32 s94, 4
    s_cbranch_scc1 L_lad15
    s_waitcnt vmcnt(4)
    s_cmp_gt_u32 s94, 3
    s_cbranch_scc1 L_lad15
    s_waitcnt vmcnt(3)
L_lad15:
    buffer_load_dwordx4 v[112:115], v1, s[44:47], s76 offen offset:0 nt
    buffer_load_dwordx4 v[116:119], v1, s[44:47], s76 offen offset:256 nt
    s_or_b32 s76, s76, s100
    s_addk_i32 s76, 8192
    s_and_b32 s76, s76, s70
    v_add_u32 v58, 1, v58
    ds_write_b32 v59, v58
    ds_read_b32 v62, v59 offset:16
    s_waitcnt vmcnt(14) lgkmcnt(0)
    v_readfirstlane_b32 s94, v62
    v_mov_b32 v46, 0
    v_dot2c_f32_bf16 v46, v120, v14
    v_dot2c_f32_bf16 v46, v121, v15
    v_dot2c_f32_bf16 v46, v122, v16
    v_dot2c_f32_bf16 v46, v123, v17
    v_mov_b32 v47, 0
    v_dot2c_f32_bf16 v47, v120, v22
    v_dot2c_f32_bf16 v47, v121, v23
    v_dot2c_f32_bf16 v47, v122, v24
    v_dot2c_f32_bf16 v47, v123, v25
    v_dot2c_f32_bf16 v46, v124, v18
    v_dot2c_f32_bf16 v46, v125, v19
    v_dot2c_f32_bf16 v46, v126, v20
    v_dot2c_f32_bf16 v46, v127, v21
    v_dot2c_f32_bf16 v47, v124, v26
    v_dot2c_f32_bf16 v47, v125, v27
    v_dot2c_f32_bf16 v47, v126, v28
    v_dot2c_f32_bf16 v47, v127, v29
    v_add_f32_dpp v49, v46, v46 row_ror:8 row_mask:0xf bank_mask:0x3
    s_nop 1
    v_add_f32_dpp v49, v47, v47 row_ror:8 row_mask:0xf bank_mask:0xc
    s_nop 1
    v_add_f32_dpp v51, v49, v49 row_half_mirror row_mask:0xf bank_mask:0xa
    s_nop 1
    v_add_f32_dpp v51, v51, v51 quad_perm:[2,3,0,1] row_mask:0xf bank_mask:0xf
    v_cndmask_b32 v53, v50, v51, s[90:91]
    s_nop 1
    v_add_f32_dpp v53, v53, v53 quad_perm:[1,0,3,2] row_mask:0xf bank_mask:0xf
    v_cndmask_b32 v136, v52, v53, s[92:93]
    s_cmp_le_u32 s94, 5
    s_cbranch_scc1 L_low16
    s_waitcnt vmcnt(12)
    s_cmp_gt_u32 s94, 10
    s_cbranch_scc1 L_lad16
    s_waitcnt vmcnt(10)
    s_cmp_gt_u32 s94, 8
    s_cbranch_scc1 L_lad16
    s_waitcnt vmcnt(8)
    s_cmp_gt_u32 s94, 7
    s_cbranch_scc1 L_lad16
    s_waitcnt vmcnt(7)
    s_cmp_gt_u32 s94, 6
    s_cbranch_scc1 L_lad16
    s_waitcnt vmcnt(6)
    s_cmp_gt_u32 s94, 5
    s_cbranch_scc1 L_lad16
L_low16:
    s_waitcnt vmcnt(5)
    s_cmp_gt_u32 s94, 4
    s_cbranch_scc1 L_lad16
    s_waitcnt vmcnt(4)
    s_cmp_gt_u32 s94, 3
    s_cbranch_scc1 L_lad16
    s_waitcnt vmcnt(3)
L_lad16:
    buffer_load_dwordx4 v[120:123], v1, s[44:47], s76 offen offset:0 nt
    buffer_load_dwordx4 v[124:127], v1, s[44:47], s76 offen offset:256 nt
    s_or_b32 s76, s76, s100
    s_addk_i32 s76, 8192
    s_and_b32 s76, s76, s70
    v_add_u32 v58, 1, v58
    ds_write_b32 v59, v58
    v_cvt_pk_bf16_f32 v136, v136, v136
    v_and_b32 v136, 0xffff0000, v136
    v_mul_f32 v136, s87, v136
    s_nop 1
    v_max_f32_dpp v188, v136, v136 row_half_mirror row_mask:0xf bank_mask:0xf
    s_nop 1
    v_max_f32_dpp v188, v188, v188 quad_perm:[1,0,3,2] row_mask:0xf bank_mask:0xf
    s_nop 1
    v_max_f32_dpp v188, v188, v188 quad_perm:[2,3,0,1] row_mask:0xf bank_mask:0xf
    v_mov_b32 v55, v188
    s_nop 1
    v_permlane16_swap_b32 v188, v55
    v_max_f32 v188, v188, v55
    v_mov_b32 v55, v188
    s_nop 1
    v_permlane32_swap_b32 v188, v55
    v_max_f32 v188, v188, v55
    v_sub_f32 v136, v136, v188
    v_exp_f32 v136, v136
    s_nop 1
    v_add_f32_dpp v189, v136, v136 row_half_mirror row_mask:0xf bank_mask:0xf
    v_cvt_pk_bf16_f32 v136, v136, v136
    s_waitcnt vmcnt(14)
    s_nop 0
    v_mov_b32_dpp v54, v136 row_newbcast:0 row_mask:0xf bank_mask:0x3
    s_nop 1
    v_mov_b32_dpp v54, v136 row_newbcast:8 row_mask:0xf bank_mask:0xc
    v_and_b32 v34, v54, v2
    v_and_b32 v35, v54, v3
    v_and_b32 v36, v54, v4
    v_and_b32 v37, v54, v5
    s_nop 1
    v_mfma_f32_16x16x32_bf16 v[128:131], v[34:37], v[64:67], 0
    v_mfma_f32_16x16x32_bf16 v[132:135], v[34:37], v[68:71], 0
    s_cmp_le_u32 s94, 5
    s_cbranch_scc1 L_low17
    s_waitcnt vmcnt(12)
    s_cmp_gt_u32 s94, 10
    s_cbranch_scc1 L_lad17
    s_waitcnt vmcnt(10)
    s_cmp_gt_u32 s94, 8
    s_cbranch_scc1 L_lad17
    s_waitcnt vmcnt(8)
    s_cmp_gt_u32 s94, 7
    s_cbranch_scc1 L_lad17
    s_waitcnt vmcnt(7)
    s_cmp_gt_u32 s94, 6
    s_cbranch_scc1 L_lad17
    s_waitcnt vmcnt(6)
    s_cmp_gt_u32 s94, 5
    s_cbranch_scc1 L_lad17
L_low17:
    s_waitcnt vmcnt(5)
    s_cmp_gt_u32 s94, 4
    s_cbranch_scc1 L_lad17
    s_waitcnt vmcnt(4)
    s_cmp_gt_u32 s94, 3
    s_cbranch_scc1 L_lad17
    s_waitcnt vmcnt(3)
L_lad17:
    s_mov_b32 s76, s101
    s_mov_b32 s100, 98304
    s_mov_b32 s70, 1998847
    buffer_load_dwordx4 v[64:67], v1, s[36:39], s76 offen offset:0 nt
    buffer_load_dwordx4 v[68:71], v1, s[36:39], s76 offen offset:256 nt
    s_or_b32 s76, s76, s100
    s_addk_i32 s76, 8192
    s_and_b32 s76, s76, s70
    v_add_u32 v58, 1, v58
    ds_write_b32 v59, v58
    ds_read_b32 v62, v59 offset:16
    v_add_f32_dpp v189, v189, v189 quad_perm:[1,0,3,2] row_mask:0xf bank_mask:0xf
    s_nop 1
    v_add_f32_dpp v189, v189, v189 quad_perm:[2,3,0,1] row_mask:0xf bank_mask:0xf
    v_mov_b32 v55, v189
    s_nop 1
    v_permlane16_swap_b32 v189, v55
    v_add_f32 v189, v189, v55
    v_mov_b32 v55, v189
    s_nop 1
    v_permlane32_swap_b32 v189, v55
    v_add_f32 v189, v189, v55
    s_lshl3_add_u32 s78, s3, 46656
    v_and_b32 v56, 8, v61
    v_lshl_add_u32 v56, v56, 2, s78
    ds_write_b64 v56, v[188:189]
    s_waitcnt vmcnt(14) lgkmcnt(0)
    v_readfirstlane_b32 s94, v62
    v_mov_b32_dpp v54, v136 row_newbcast:4 row_mask:0xf bank_mask:0x3
    s_nop 1
    v_mov_b32_dpp v54, v136 row_newbcast:12 row_mask:0xf bank_mask:0xc
    v_and_b32 v34, v54, v2
    v_and_b32 v35, v54, v3
    v_and_b32 v36, v54, v4
    v_and_b32 v37, v54, v5
    s_nop 1
    v_mfma_f32_16x16x32_bf16 v[128:131], v[34:37], v[72:75], v[128:131]
    v_mfma_f32_16x16x32_bf16 v[132:135], v[34:37], v[76:79], v[132:135]
    s_cmp_le_u32 s94, 5
    s_cbranch_scc1 L_low18
    s_waitcnt vmcnt(12)
    s_cmp_gt_u32 s94, 10
    s_cbranch_scc1 L_lad18
    s_waitcnt vmcnt(10)
    s_cmp_gt_u32 s94, 8
    s_cbranch_scc1 L_lad18
    s_waitcnt vmcnt(8)
    s_cmp_gt_u32 s94, 7
    s_cbranch_scc1 L_lad18
    s_waitcnt vmcnt(7)
    s_cmp_gt_u32 s94, 6
    s_cbranch_scc1 L_lad18
    s_waitcnt vmcnt(6)
    s_cmp_gt_u32 s94, 5
    s_cbranch_scc1 L_lad18
L_low18:
    s_waitcnt vmcnt(5)
    s_cmp_gt_u32 s94, 4
    s_cbranch_scc1 L_lad18
    s_waitcnt vmcnt(4)
    s_cmp_gt_u32 s94, 3
    s_cbranch_scc1 L_lad18
    s_waitcnt vmcnt(3)
L_lad18:
    buffer_load_dwordx4 v[72:75], v1, s[36:39], s76 offen offset:0 nt
    buffer_load_dwordx4 v[76:79], v1, s[36:39], s76 offen offset:256 nt
    s_or_b32 s76, s76, s100
    s_addk_i32 s76, 8192
    s_and_b32 s76, s76, s70
    v_add_u32 v58, 1, v58
    ds_write_b32 v59, v58
    v_cvt_pk_bf16_f32 v30, v30, v30
    v_and_b32 v30, 0xffff0000, v30
    v_cvt_pk_bf16_f32 v31, v31, v31
    v_and_b32 v31, 0xffff0000, v31
    v_cvt_pk_bf16_f32 v32, v32, v32
    v_and_b32 v32, 0xffff0000, v32
    v_cvt_pk_bf16_f32 v33, v33, v33
    v_and_b32 v33, 0xffff0000, v33
    v_max3_f32 v186, v30, v31, v32
    v_max_f32 v186, v186, v33
    s_nop 1
    v_max_f32_dpp v186, v186, v186 row_ror:8 row_mask:0xf bank_mask:0xf
    s_nop 1
    v_max_f32_dpp v186, v186, v186 row_ror:4 row_mask:0xf bank_mask:0xf
    s_nop 1
    v_max_f32_dpp v186, v186, v186 row_ror:2 row_mask:0xf bank_mask:0xf
    s_nop 1
    v_max_f32_dpp v186, v186, v186 row_ror:1 row_mask:0xf bank_mask:0xf
    v_mov_b32 v55, v186
    s_nop 1
    v_permlane16_swap_b32 v186, v55
    v_max_f32 v186, v186, v55
    v_mov_b32 v55, v186
    s_nop 1
    v_permlane32_swap_b32 v186, v55
    v_max_f32 v186, v186, v55
    v_mul_f32 v186, s87, v186
    v_fma_f32 v30, v30, s87, -v186
    v_fma_f32 v31, v31, s87, -v186
    v_fma_f32 v32, v32, s87, -v186
    v_fma_f32 v33, v33, s87, -v186
    v_exp_f32 v30, v30
    v_exp_f32 v31, v31
    v_exp_f32 v32, v32
    v_exp_f32 v33, v33
    v_add_f32 v187, v30, v31
    v_add_f32 v54, v32, v33
    v_add_f32 v187, v187, v54
    v_cvt_pk_bf16_f32 v30, v30, v30
    v_cvt_pk_bf16_f32 v31, v31, v31
    v_cvt_pk_bf16_f32 v32, v32, v32
    v_cvt_pk_bf16_f32 v33, v33, v33
    s_waitcnt vmcnt(14)
    v_mov_b32_dpp v54, v136 row_newbcast:2 row_mask:0xf bank_mask:0x3
    s_nop 1
    v_mov_b32_dpp v54, v136 row_newbcast:10 row_mask:0xf bank_mask:0xc
    v_and_b32 v34, v54, v2
    v_and_b32 v35, v54, v3
    v_and_b32 v36, v54, v4
    v_and_b32 v37, v54, v5
    s_nop 1
    v_mfma_f32_16x16x32_bf16 v[128:131], v[34:37], v[80:83], v[128:131]
    v_mfma_f32_16x16x32_bf16 v[132:135], v[34:37], v[84:87], v[132:135]
    s_cmp_le_u32 s94, 5
    s_cbranch_scc1 L_low19
    s_waitcnt vmcnt(12)
    s_cmp_gt_u32 s94, 10
    s_cbranch_scc1 L_lad19
    s_waitcnt vmcnt(10)
    s_cmp_gt_u32 s94, 8
    s_cbranch_scc1 L_lad19
    s_waitcnt vmcnt(8)
    s_cmp_gt_u32 s94, 7
    s_cbranch_scc1 L_lad19
    s_waitcnt vmcnt(7)
    s_cmp_gt_u32 s94, 6
    s_cbranch_scc1 L_lad19
    s_waitcnt vmcnt(6)
    s_cmp_gt_u32 s94, 5
    s_cbranch_scc1 L_lad19
L_low19:
    s_waitcnt vmcnt(5)
    s_cmp_gt_u32 s94, 4
    s_cbranch_scc1 L_lad19
    s_waitcnt vmcnt(4)
    s_cmp_gt_u32 s94, 3
    s_cbranch_scc1 L_lad19
    s_waitcnt vmcnt(3)
L_lad19:
    buffer_load_dwordx4 v[80:83], v1, s[36:39], s76 offen offset:0 nt
    buffer_load_dwordx4 v[84:87], v1, s[36:39], s76 offen offset:256 nt
    s_or_b32 s76, s76, s100
    s_addk_i32 s76, 8192
    s_and_b32 s76, s76, s70
    v_add_u32 v58, 1, v58
    ds_write_b32 v59, v58
    ds_read_b32 v62, v59 offset:16
    v_add_f32_dpp v187, v187, v187 row_ror:8 row_mask:0xf bank_mask:0xf
    s_nop 1
    v_add_f32_dpp v187, v187, v187 row_ror:4 row_mask:0xf bank_mask:0xf
    s_nop 1
    v_add_f32_dpp v187, v187, v187 row_ror:2 row_mask:0xf bank_mask:0xf
    s_nop 1
    v_add_f32_dpp v187, v187, v187 row_ror:1 row_mask:0xf bank_mask:0xf
    v_mov_b32 v55, v187
    s_nop 1
    v_permlane16_swap_b32 v187, v55
    v_add_f32 v187, v187, v55
    v_mov_b32 v55, v187
    s_nop 1
    v_permlane32_swap_b32 v187, v55
    v_add_f32 v187, v187, v55
    v_mov_b32 v38, 0
    v_mov_b32 v39, 0
    v_mov_b32 v40, 0
    v_mov_b32 v41, 0
    v_mov_b32 v42, 0
    v_mov_b32 v43, 0
    v_mov_b32 v44, 0
    v_mov_b32 v45, 0
    s_lshl3_add_u32 s78, s3, 46720
    v_mov_b32 v56, s78
    ds_write_b64 v56, v[186:187]
    s_waitcnt vmcnt(14) lgkmcnt(0)
    v_readfirstlane_b32 s94, v62
    v_mov_b32_dpp v54, v136 row_newbcast:6 row_mask:0xf bank_mask:0x3
    s_nop 1
    v_mov_b32_dpp v54, v136 row_newbcast:14 row_mask:0xf bank_mask:0xc
    v_and_b32 v34, v54, v2
    v_and_b32 v35, v54, v3
    v_and_b32 v36, v54, v4
    v_and_b32 v37, v54, v5
    s_nop 1
    v_mfma_f32_16x16x32_bf16 v[128:131], v[34:37], v[88:91], v[128:131]
    v_mfma_f32_16x16x32_bf16 v[132:135], v[34:37], v[92:95], v[132:135]
    s_cmp_le_u32 s94, 5
    s_cbranch_scc1 L_low20
    s_waitcnt vmcnt(12)
    s_cmp_gt_u32 s94, 10
    s_cbranch_scc1 L_lad20
    s_waitcnt vmcnt(10)
    s_cmp_gt_u32 s94, 8
    s_cbranch_scc1 L_lad20
    s_waitcnt vmcnt(8)
    s_cmp_gt_u32 s94, 7
    s_cbranch_scc1 L_lad20
    s_waitcnt vmcnt(7)
    s_cmp_gt_u32 s94, 6
    s_cbranch_scc1 L_lad20
    s_waitcnt vmcnt(6)
    s_cmp_gt_u32 s94, 5
    s_cbranch_scc1 L_lad20
L_low20:
    s_waitcnt vmcnt(5)
    s_cmp_gt_u32 s94, 4
    s_cbranch_scc1 L_lad20
    s_waitcnt vmcnt(4)
    s_cmp_gt_u32 s94, 3
    s_cbranch_scc1 L_lad20
    s_waitcnt vmcnt(3)
L_lad20:
    buffer_load_dwordx4 v[88:91], v1, s[36:39], s76 offen offset:0 nt
    buffer_load_dwordx4 v[92:95], v1, s[36:39], s76 offen offset:256 nt
    s_or_b32 s76, s76, s100
    s_addk_i32 s76, 8192
    s_and_b32 s76, s76, s70
    v_add_u32 v58, 1, v58
    ds_write_b32 v59, v58
    v_lshrrev_b32 v54, 2, v61
    v_and_b32 v56, 3, v61
    v_lshlrev_b32 v176, 4, v0
    v_lshl_add_u32 v178, v60, 3, v54
    v_lshlrev_b32 v178, 7, v178
    v_lshl_add_u32 v178, v56, 3, v178
    v_lshrrev_b32 v54, 3, v0
    v_mul_u32_u24 v54, 896, v54
    v_and_b32 v56, 7, v0
    v_lshl_add_u32 v183, v56, 4, v54
    s_waitcnt vmcnt(14)
    v_mov_b32_dpp v54, v136 row_newbcast:1 row_mask:0xf bank_mask:0x3
    s_nop 1
    v_mov_b32_dpp v54, v136 row_newbcast:9 row_mask:0xf bank_mask:0xc
    v_and_b32 v34, v54, v2
    v_and_b32 v35, v54, v3
    v_and_b32 v36, v54, v4
    v_and_b32 v37, v54, v5
    s_nop 1
    v_mfma_f32_16x16x32_bf16 v[128:131], v[34:37], v[96:99], v[128:131]
    v_mfma_f32_16x16x32_bf16 v[132:135], v[34:37], v[100:103], v[132:135]
    s_cmp_le_u32 s94, 5
    s_cbranch_scc1 L_low21
    s_waitcnt vmcnt(12)
    s_cmp_gt_u32 s94, 10
    s_cbranch_scc1 L_lad21
    s_waitcnt vmcnt(10)
    s_cmp_gt_u32 s94, 8
    s_cbranch_scc1 L_lad21
    s_waitcnt vmcnt(8)
    s_cmp_gt_u32 s94, 7
    s_cbranch_scc1 L_lad21
    s_waitcnt vmcnt(7)
    s_cmp_gt_u32 s94, 6
    s_cbranch_scc1 L_lad21
    s_waitcnt vmcnt(6)
    s_cmp_gt_u32 s94, 5
    s_cbranch_scc1 L_lad21
L_low21:
    s_waitcnt vmcnt(5)
    s_cmp_gt_u32 s94, 4
    s_cbranch_scc1 L_lad21
    s_waitcnt vmcnt(4)
    s_cmp_gt_u32 s94, 3
    s_cbranch_scc1 L_lad21
    s_waitcnt vmcnt(3)
L_lad21:
    buffer_load_dwordx4 v[96:99], v1, s[36:39], s76 offen offset:0 nt
    buffer_load_dwordx4 v[100:103], v1, s[36:39], s76 offen offset:256 nt
    s_or_b32 s76, s76, s100
    s_addk_i32 s76, 8192
    s_and_b32 s76, s76, s70
    v_add_u32 v58, 1, v58
    ds_write_b32 v59, v58
    ds_read_b32 v62, v59 offset:16
    v_bfe_u32 v54, v0, 3, 2
    v_xor_b32 v54, s3, v54
    v_lshl_add_u32 v178, v54, 5, v178
    v_and_b32 v54, 16, v0
    v_lshlrev_b32 v54, 1, v54
    v_xor_b32 v183, v54, v183
    v_xor_b32 v185, 64, v183
    s_lshl_b32 s64, s3, 12
    v_add_u32 v54, 0, v60
    v_mul_u32_u24 v177, 114688, v54
    v_bfe_u32 v56, s71, v54, 1
    v_lshl_add_u32 v177, v56, 13, v177
    v_lshl_add_u32 v177, v61, 2, v177
    v_add_u32 v54, 4, v60
    v_mul_u32_u24 v184, 114688, v54
    v_bfe_u32 v56, s71, v54, 1
    v_lshl_add_u32 v184, v56, 13, v184
    v_lshl_add_u32 v184, v61, 2, v184
    v_mov_b32 v206, 0xfffff000
    v_mov_b32 v54, s65
    v_mov_b32 v55, s66
    v_cndmask_b32 v54, v54, v55, s[92:93]
    v_mov_b32 v56, s67
    v_mov_b32 v55, s68
    v_cndmask_b32 v56, v56, v55, s[92:93]
    v_cndmask_b32 v207, v54, v56, s[90:91]
    v_and_b32 v54, 1, v60
    v_lshlrev_b32 v54, 4, v54
    v_lshl_add_u32 v54, v61, 5, v54
    s_lshl_b32 s78, s3, 10
    s_add_u32 s78, s78, 32768
    v_add_u32 v179, s78, v54
    s_waitcnt vmcnt(14) lgkmcnt(0)
    v_readfirstlane_b32 s94, v62
    v_mov_b32_dpp v54, v136 row_newbcast:5 row_mask:0xf bank_mask:0x3
    s_nop 1
    v_mov_b32_dpp v54, v136 row_newbcast:13 row_mask:0xf bank_mask:0xc
    v_and_b32 v34, v54, v2
    v_and_b32 v35, v54, v3
    v_and_b32 v36, v54, v4
    v_and_b32 v37, v54, v5
    s_nop 1
    v_mfma_f32_16x16x32_bf16 v[128:131], v[34:37], v[104:107], v[128:131]
    v_mfma_f32_16x16x32_bf16 v[132:135], v[34:37], v[108:111], v[132:135]
    s_cmp_le_u32 s94, 5
    s_cbranch_scc1 L_low22
    s_waitcnt vmcnt(12)
    s_cmp_gt_u32 s94, 10
    s_cbranch_scc1 L_lad22
    s_waitcnt vmcnt(10)
    s_cmp_gt_u32 s94, 8
    s_cbranch_scc1 L_lad22
    s_waitcnt vmcnt(8)
    s_cmp_gt_u32 s94, 7
    s_cbranch_scc1 L_lad22
    s_waitcnt vmcnt(7)
    s_cmp_gt_u32 s94, 6
    s_cbranch_scc1 L_lad22
    s_waitcnt vmcnt(6)
    s_cmp_gt_u32 s94, 5
    s_cbranch_scc1 L_lad22
L_low22:
    s_waitcnt vmcnt(5)
    s_cmp_gt_u32 s94, 4
    s_cbranch_scc1 L_lad22
    s_waitcnt vmcnt(4)
    s_cmp_gt_u32 s94, 3
    s_cbranch_scc1 L_lad22
    s_waitcnt vmcnt(3)
L_lad22:
    buffer_load_dwordx4 v[104:107], v1, s[36:39], s76 offen offset:0 nt
    buffer_load_dwordx4 v[108:111], v1, s[36:39], s76 offen offset:256 nt
    s_or_b32 s76, s76, s100
    s_addk_i32 s76, 8192
    s_and_b32 s76, s76, s70
    v_add_u32 v58, 1, v58
    ds_write_b32 v59, v58
    s_waitcnt vmcnt(14)
    v_mov_b32_dpp v54, v136 row_newbcast:3 row_mask:0xf bank_mask:0x3
    s_nop 1
    v_mov_b32_dpp v54, v136 row_newbcast:11 row_mask:0xf bank_mask:0xc
    v_and_b32 v34, v54, v2
    v_and_b32 v35, v54, v3
    v_and_b32 v36, v54, v4
    v_and_b32 v37, v54, v5
    s_nop 1
    v_mfma_f32_16x16x32_bf16 v[128:131], v[34:37], v[112:115], v[128:131]
    v_mfma_f32_16x16x32_bf16 v[132:135], v[34:37], v[116:119], v[132:135]
    s_cmp_le_u32 s94, 5
    s_cbranch_scc1 L_low23
    s_waitcnt vmcnt(12)
    s_cmp_gt_u32 s94, 10
    s_cbranch_scc1 L_lad23
    s_waitcnt vmcnt(10)
    s_cmp_gt_u32 s94, 8
    s_cbranch_scc1 L_lad23
    s_waitcnt vmcnt(8)
    s_cmp_gt_u32 s94, 7
    s_cbranch_scc1 L_lad23
    s_waitcnt vmcnt(7)
    s_cmp_gt_u32 s94, 6
    s_cbranch_scc1 L_lad23
    s_waitcnt vmcnt(6)
    s_cmp_gt_u32 s94, 5
    s_cbranch_scc1 L_lad23
L_low23:
    s_waitcnt vmcnt(5)
    s_cmp_gt_u32 s94, 4
    s_cbranch_scc1 L_lad23
    s_waitcnt vmcnt(4)
    s_cmp_gt_u32 s94, 3
    s_cbranch_scc1 L_lad23
    s_waitcnt vmcnt(3)
L_lad23:
    buffer_load_dwordx4 v[112:115], v1, s[36:39], s76 offen offset:0 nt
    buffer_load_dwordx4 v[116:119], v1, s[36:39], s76 offen offset:256 nt
    s_or_b32 s76, s76, s100
    s_addk_i32 s76, 8192
    s_and_b32 s76, s76, s70
    v_add_u32 v58, 1, v58
    ds_write_b32 v59, v58
    ds_read_b32 v62, v59 offset:16
    s_waitcnt vmcnt(14) lgkmcnt(0)
    v_readfirstlane_b32 s94, v62
    v_mov_b32_dpp v54, v136 row_newbcast:7 row_mask:0xf bank_mask:0x3
    s_nop 1
    v_mov_b32_dpp v54, v136 row_newbcast:15 row_mask:0xf bank_mask:0xc
    v_and_b32 v34, v54, v2
    v_and_b32 v35, v54, v3
    v_and_b32 v36, v54, v4
    v_and_b32 v37, v54, v5
    s_nop 1
    v_mfma_f32_16x16x32_bf16 v[128:131], v[34:37], v[120:123], v[128:131]
    v_mfma_f32_16x16x32_bf16 v[132:135], v[34:37], v[124:127], v[132:135]
    s_cmp_le_u32 s94, 5
    s_cbranch_scc1 L_low24
    s_waitcnt vmcnt(12)
    s_cmp_gt_u32 s94, 10
    s_cbranch_scc1 L_lad24
    s_waitcnt vmcnt(10)
    s_cmp_gt_u32 s94, 8
    s_cbranch_scc1 L_lad24
    s_waitcnt vmcnt(8)
    s_cmp_gt_u32 s94, 7
    s_cbranch_scc1 L_lad24
    s_waitcnt vmcnt(7)
    s_cmp_gt_u32 s94, 6
    s_cbranch_scc1 L_lad24
    s_waitcnt vmcnt(6)
    s_cmp_gt_u32 s94, 5
    s_cbranch_scc1 L_lad24
L_low24:
    s_waitcnt vmcnt(5)
    s_cmp_gt_u32 s94, 4
    s_cbranch_scc1 L_lad24
    s_waitcnt vmcnt(4)
    s_cmp_gt_u32 s94, 3
    s_cbranch_scc1 L_lad24
    s_waitcnt vmcnt(3)
L_lad24:
    buffer_load_dwordx4 v[120:123], v1, s[36:39], s76 offen offset:0 nt
    buffer_load_dwordx4 v[124:127], v1, s[36:39], s76 offen offset:256 nt
    s_or_b32 s76, s76, s100
    s_addk_i32 s76, 8192
    s_and_b32 s76, s76, s70
    v_add_u32 v58, 1, v58
    ds_write_b32 v59, v58
    v_lshrrev_b32 v55, 1, v60
    v_lshl_add_u32 v54, v55, 12, v179
    ds_write_b128 v54, v[128:131]
    ds_write_b128 v54, v[132:135] offset:512
    v_lshl_add_u32 v179, v55, 9, v179
    s_mov_b32 s77, 0
L_v:
L_v_body:
    s_waitcnt vmcnt(14)
    v_and_b32_dpp v34, v30, v2 row_newbcast:0 row_mask:0xf bank_mask:0xf
    v_and_b32_dpp v35, v30, v3 row_newbcast:0 row_mask:0xf bank_mask:0xf
    v_and_b32_dpp v36, v30, v4 row_newbcast:0 row_mask:0xf bank_mask:0xf
    v_and_b32_dpp v37, v30, v5 row_newbcast:0 row_mask:0xf bank_mask:0xf
    s_nop 1
    v_mfma_f32_16x16x32_bf16 v[38:41], v[34:37], v[64:67], v[38:41]
    v_mfma_f32_16x16x32_bf16 v[42:45], v[34:37], v[68:71], v[42:45]
    s_cmp_le_u32 s94, 5
    s_cbranch_scc1 L_low25
    s_waitcnt vmcnt(12)
    s_cmp_gt_u32 s94, 10
    s_cbranch_scc1 L_lad25
    s_waitcnt vmcnt(10)
    s_cmp_gt_u32 s94, 8
    s_cbranch_scc1 L_lad25
    s_waitcnt vmcnt(8)
    s_cmp_gt_u32 s94, 7
    s_cbranch_scc1 L_lad25
    s_waitcnt vmcnt(7)
    s_cmp_gt_u32 s94, 6
    s_cbranch_scc1 L_lad25
    s_waitcnt vmcnt(6)
    s_cmp_gt_u32 s94, 5
    s_cbranch_scc1 L_lad25
L_low25:
    s_waitcnt vmcnt(5)
    s_cmp_gt_u32 s94, 4
    s_cbranch_scc1 L_lad25
    s_waitcnt vmcnt(4)
    s_cmp_gt_u32 s94, 3
    s_cbranch_scc1 L_lad25
    s_waitcnt vmcnt(3)
L_lad25:
    buffer_load_dwordx4 v[64:67], v1, s[36:39], s76 offen offset:0 nt
    buffer_load_dwordx4 v[68:71], v1, s[36:39], s76 offen offset:256 nt
    s_or_b32 s76, s76, s100
    s_addk_i32 s76, 8192
    s_and_b32 s76, s76, s70
    v_add_u32 v58, 1, v58
    ds_write_b32 v59, v58
    ds_read_b32 v62, v59 offset:16
    s_waitcnt vmcnt(14) lgkmcnt(0)
    v_readfirstlane_b32 s94, v62
    v_and_b32_dpp v34, v30, v2 row_newbcast:8 row_mask:0xf bank_mask:0xf
    v_and_b32_dpp v35, v30, v3 row_newbcast:8 row_mask:0xf bank_mask:0xf
    v_and_b32_dpp v36, v30, v4 row_newbcast:8 row_mask:0xf bank_mask:0xf
    v_and_b32_dpp v37, v30, v5 row_newbcast:8 row_mask:0xf bank_mask:0xf
    s_nop 1
    v_mfma_f32_16x16x32_bf16 v[38:41], v[34:37], v[72:75], v[38:41]
    v_mfma_f32_16x16x32_bf16 v[42:45], v[34:37], v[76:79], v[42:45]
    s_cmp_le_u32 s94, 5
    s_cbranch_scc1 L_low26
    s_waitcnt vmcnt(12)
    s_cmp_gt_u32 s94, 10
    s_cbranch_scc1 L_lad26
    s_waitcnt vmcnt(10)
    s_cmp_gt_u32 s94, 8
    s_cbranch_scc1 L_lad26
    s_waitcnt vmcnt(8)
    s_cmp_gt_u32 s94, 7
    s_cbranch_scc1 L_lad26
    s_waitcnt vmcnt(7)
    s_cmp_gt_u32 s94, 6
    s_cbranch_scc1 L_lad26
    s_waitcnt vmcnt(6)
    s_cmp_gt_u32 s94, 5
    s_cbranch_scc1 L_lad26
L_low26:
    s_waitcnt vmcnt(5)
    s_cmp_gt_u32 s94, 4
    s_cbranch_scc1 L_lad26
    s_waitcnt vmcnt(4)
    s_cmp_gt_u32 s94, 3
    s_cbranch_scc1 L_lad26
    s_waitcnt vmcnt(3)
L_lad26:
    buffer_load_dwordx4 v[72:75], v1, s[36:39], s76 offen offset:0 nt
    buffer_load_dwordx4 v[76:79], v1, s[36:39], s76 offen offset:256 nt
    s_or_b32 s76, s76, s100
    s_addk_i32 s76, 8192
    s_and_b32 s76, s76, s70
    v_add_u32 v58, 1, v58
    ds_write_b32 v59, v58
    s_waitcnt vmcnt(14)
    v_and_b32_dpp v34, v30, v2 row_newbcast:4 row_mask:0xf bank_mask:0xf
    v_and_b32_dpp v35, v30, v3 row_newbcast:4 row_mask:0xf bank_mask:0xf
    v_and_b32_dpp v36, v30, v4 row_newbcast:4 row_mask:0xf bank_mask:0xf
    v_and_b32_dpp v37, v30, v5 row_newbcast:4 row_mask:0xf bank_mask:0xf
    s_nop 1
    v_mfma_f32_16x16x32_bf16 v[38:41], v[34:37], v[80:83], v[38:41]
    v_mfma_f32_16x16x32_bf16 v[42:45], v[34:37], v[84:87], v[42:45]
    s_cmp_le_u32 s94, 5
    s_cbranch_scc1 L_low27
    s_waitcnt vmcnt(12)
    s_cmp_gt_u32 s94, 10
    s_cbranch_scc1 L_lad27
    s_waitcnt vmcnt(10)
    s_cmp_gt_u32 s94, 8
    s_cbranch_scc1 L_lad27
    s_waitcnt vmcnt(8)
    s_cmp_gt_u32 s94, 7
    s_cbranch_scc1 L_lad27
    s_waitcnt vmcnt(7)
    s_cmp_gt_u32 s94, 6
    s_cbranch_scc1 L_lad27
    s_waitcnt vmcnt(6)
    s_cmp_gt_u32 s94, 5
    s_cbranch_scc1 L_lad27
L_low27:
    s_waitcnt vmcnt(5)
    s_cmp_gt_u32 s94, 4
    s_cbranch_scc1 L_lad27
    s_waitcnt vmcnt(4)
    s_cmp_gt_u32 s94, 3
    s_cbranch_scc1 L_lad27
    s_waitcnt vmcnt(3)
L_lad27:
    buffer_load_dwordx4 v[80:83], v1, s[36:39], s76 offen offset:0 nt
    buffer_load_dwordx4 v[84:87], v1, s[36:39], s76 offen offset:256 nt
    s_or_b32 s76, s76, s100
    s_addk_i32 s76, 8192
    s_and_b32 s76, s76, s70
    v_add_u32 v58, 1, v58
    ds_write_b32 v59, v58
    ds_read_b32 v62, v59 offset:16
    s_waitcnt vmcnt(14) lgkmcnt(0)
    v_readfirstlane_b32 s94, v62
    v_and_b32_dpp v34, v30, v2 row_newbcast:12 row_mask:0xf bank_mask:0xf
    v_and_b32_dpp v35, v30, v3 row_newbcast:12 row_mask:0xf bank_mask:0xf
    v_and_b32_dpp v36, v30, v4 row_newbcast:12 row_mask:0xf bank_mask:0xf
    v_and_b32_dpp v37, v30, v5 row_newbcast:12 row_mask:0xf bank_mask:0xf
    s_nop 1
    v_mfma_f32_16x16x32_bf16 v[38:41], v[34:37], v[88:91], v[38:41]
    v_mfma_f32_16x16x32_bf16 v[42:45], v[34:37], v[92:95], v[42:45]
    v_mov_b32_dpp v52, v30 quad_perm:[1,2,3,0] row_mask:0xf bank_mask:0xf
    v_mov_b32 v30, v31
    v_mov_b32 v31, v32
    v_mov_b32 v32, v33
    v_mov_b32 v33, v52
    s_cmp_le_u32 s94, 5
    s_cbranch_scc1 L_low28
    s_waitcnt vmcnt(12)
    s_cmp_gt_u32 s94, 10
    s_cbranch_scc1 L_lad28
    s_waitcnt vmcnt(10)
    s_cmp_gt_u32 s94, 8
    s_cbranch_scc1 L_lad28
    s_waitcnt vmcnt(8)
    s_cmp_gt_u32 s94, 7
    s_cbranch_scc1 L_lad28
    s_waitcnt vmcnt(7)
    s_cmp_gt_u32 s94, 6
    s_cbranch_scc1 L_lad28
    s_waitcnt vmcnt(6)
    s_cmp_gt_u32 s94, 5
    s_cbranch_scc1 L_lad28
L_low28:
    s_waitcnt vmcnt(5)
    s_cmp_gt_u32 s94, 4
    s_cbranch_scc1 L_lad28
    s_waitcnt vmcnt(4)
    s_cmp_gt_u32 s94, 3
    s_cbranch_scc1 L_lad28
    s_waitcnt vmcnt(3)
L_lad28:
    buffer_load_dwordx4 v[88:91], v1, s[36:39], s76 offen offset:0 nt
    buffer_load_dwordx4 v[92:95], v1, s[36:39], s76 offen offset:256 nt
    s_or_b32 s76, s76, s100
    s_addk_i32 s76, 8192
    s_and_b32 s76, s76, s70
    v_add_u32 v58, 1, v58
    ds_write_b32 v59, v58
    s_waitcnt vmcnt(14)
    v_and_b32_dpp v34, v30, v2 row_newbcast:0 row_mask:0xf bank_mask:0xf
    v_and_b32_dpp v35, v30, v3 row_newbcast:0 row_mask:0xf bank_mask:0xf
    v_and_b32_dpp v36, v30, v4 row_newbcast:0 row_mask:0xf bank_mask:0xf
    v_and_b32_dpp v37, v30, v5 row_newbcast:0 row_mask:0xf bank_mask:0xf
    s_nop 1
    v_mfma_f32_16x16x32_bf16 v[38:41], v[34:37], v[96:99], v[38:41]
    v_mfma_f32_16x16x32_bf16 v[42:45], v[34:37], v[100:103], v[42:45]
    s_cmp_le_u32 s94, 5
    s_cbranch_scc1 L_low29
    s_waitcnt vmcnt(12)
    s_cmp_gt_u32 s94, 10
    s_cbranch_scc1 L_lad29
    s_waitcnt vmcnt(10)
    s_cmp_gt_u32 s94, 8
    s_cbranch_scc1 L_lad29
    s_waitcnt vmcnt(8)
    s_cmp_gt_u32 s94, 7
    s_cbranch_scc1 L_lad29
    s_waitcnt vmcnt(7)
    s_cmp_gt_u32 s94, 6
    s_cbranch_scc1 L_lad29
    s_waitcnt vmcnt(6)
    s_cmp_gt_u32 s94, 5
    s_cbranch_scc1 L_lad29
L_low29:
    s_waitcnt vmcnt(5)
    s_cmp_gt_u32 s94, 4
    s_cbranch_scc1 L_lad29
    s_waitcnt vmcnt(4)
    s_cmp_gt_u32 s94, 3
    s_cbranch_scc1 L_lad29
    s_waitcnt vmcnt(3)
L_lad29:
    buffer_load_dwordx4 v[96:99], v1, s[36:39], s76 offen offset:0 nt
    buffer_load_dwordx4 v[100:103], v1, s[36:39], s76 offen offset:256 nt
    s_or_b32 s76, s76, s100
    s_addk_i32 s76, 8192
    s_and_b32 s76, s76, s70
    v_add_u32 v58, 1, v58
    ds_write_b32 v59, v58
    ds_read_b32 v62, v59 offset:16
    s_waitcnt vmcnt(14) lgkmcnt(0)
    v_readfirstlane_b32 s94, v62
    v_and_b32_dpp v34, v30, v2 row_newbcast:8 row_mask:0xf bank_mask:0xf
    v_and_b32_dpp v35, v30, v3 row_newbcast:8 row_mask:0xf bank_mask:0xf
    v_and_b32_dpp v36, v30, v4 row_newbcast:8 row_mask:0xf bank_mask:0xf
    v_and_b32_dpp v37, v30, v5 row_newbcast:8 row_mask:0xf bank_mask:0xf
    s_nop 1
    v_mfma_f32_16x16x32_bf16 v[38:41], v[34:37], v[104:107], v[38:41]
    v_mfma_f32_16x16x32_bf16 v[42:45], v[34:37], v[108:111], v[42:45]
    s_cmp_le_u32 s94, 5
    s_cbranch_scc1 L_low30
    s_waitcnt vmcnt(12)
    s_cmp_gt_u32 s94, 10
    s_cbranch_scc1 L_lad30
    s_waitcnt vmcnt(10)
    s_cmp_gt_u32 s94, 8
    s_cbranch_scc1 L_lad30
    s_waitcnt vmcnt(8)
    s_cmp_gt_u32 s94, 7
    s_cbranch_scc1 L_lad30
    s_waitcnt vmcnt(7)
    s_cmp_gt_u32 s94, 6
    s_cbranch_scc1 L_lad30
    s_waitcnt vmcnt(6)
    s_cmp_gt_u32 s94, 5
    s_cbranch_scc1 L_lad30
L_low30:
    s_waitcnt vmcnt(5)
    s_cmp_gt_u32 s94, 4
    s_cbranch_scc1 L_lad30
    s_waitcnt vmcnt(4)
    s_cmp_gt_u32 s94, 3
    s_cbranch_scc1 L_lad30
    s_waitcnt vmcnt(3)
L_lad30:
    buffer_load_dwordx4 v[104:107], v1, s[36:39], s76 offen offset:0 nt
    buffer_load_dwordx4 v[108:111], v1, s[36:39], s76 offen offset:256 nt
    s_or_b32 s76, s76, s100
    s_addk_i32 s76, 8192
    s_and_b32 s76, s76, s70
    v_add_u32 v58, 1, v58
    ds_write_b32 v59, v58
    s_waitcnt vmcnt(14)
    v_and_b32_dpp v34, v30, v2 row_newbcast:4 row_mask:0xf bank_mask:0xf
    v_and_b32_dpp v35, v30, v3 row_newbcast:4 row_mask:0xf bank_mask:0xf
    v_and_b32_dpp v36, v30, v4 row_newbcast:4 row_mask:0xf bank_mask:0xf
    v_and_b32_dpp v37, v30, v5 row_newbcast:4 row_mask:0xf bank_mask:0xf
    s_nop 1
    v_mfma_f32_16x16x32_bf16 v[38:41], v[34:37], v[112:115], v[38:41]
    v_mfma_f32_16x16x32_bf16 v[42:45], v[34:37], v[116:119], v[42:45]
    s_cmp_le_u32 s94, 5
    s_cbranch_scc1 L_low31
    s_waitcnt vmcnt(12)
    s_cmp_gt_u32 s94, 10
    s_cbranch_scc1 L_lad31
    s_waitcnt vmcnt(10)
    s_cmp_gt_u32 s94, 8
    s_cbranch_scc1 L_lad31
    s_waitcnt vmcnt(8)
    s_cmp_gt_u32 s94, 7
    s_cbranch_scc1 L_lad31
    s_waitcnt vmcnt(7)
    s_cmp_gt_u32 s94, 6
    s_cbranch_scc1 L_lad31
    s_waitcnt vmcnt(6)
    s_cmp_gt_u32 s94, 5
    s_cbranch_scc1 L_lad31
L_low31:
    s_waitcnt vmcnt(5)
    s_cmp_gt_u32 s94, 4
    s_cbranch_scc1 L_lad31
    s_waitcnt vmcnt(4)
    s_cmp_gt_u32 s94, 3
    s_cbranch_scc1 L_lad31
    s_waitcnt vmcnt(3)
L_lad31:
    buffer_load_dwordx4 v[112:115], v1, s[36:39], s76 offen offset:0 nt
    buffer_load_dwordx4 v[116:119], v1, s[36:39], s76 offen offset:256 nt
    s_or_b32 s76, s76, s100
    s_addk_i32 s76, 8192
    s_and_b32 s76, s76, s70
    v_add_u32 v58, 1, v58
    ds_write_b32 v59, v58
    ds_read_b32 v62, v59 offset:16
    s_waitcnt vmcnt(14) lgkmcnt(0)
    v_readfirstlane_b32 s94, v62
    v_and_b32_dpp v34, v30, v2 row_newbcast:12 row_mask:0xf bank_mask:0xf
    v_and_b32_dpp v35, v30, v3 row_newbcast:12 row_mask:0xf bank_mask:0xf
    v_and_b32_dpp v36, v30, v4 row_newbcast:12 row_mask:0xf bank_mask:0xf
    v_and_b32_dpp v37, v30, v5 row_newbcast:12 row_mask:0xf bank_mask:0xf
    s_nop 1
    v_mfma_f32_16x16x32_bf16 v[38:41], v[34:37], v[120:123], v[38:41]
    v_mfma_f32_16x16x32_bf16 v[42:45], v[34:37], v[124:127], v[42:45]
    v_mov_b32_dpp v52, v30 quad_perm:[1,2,3,0] row_mask:0xf bank_mask:0xf
    v_mov_b32 v30, v31
    v_mov_b32 v31, v32
    v_mov_b32 v32, v33
    v_mov_b32 v33, v52
    s_cmp_le_u32 s94, 5
    s_cbranch_scc1 L_low32
    s_waitcnt vmcnt(12)
    s_cmp_gt_u32 s94, 10
    s_cbranch_scc1 L_lad32
    s_waitcnt vmcnt(10)
    s_cmp_gt_u32 s94, 8
    s_cbranch_scc1 L_lad32
    s_waitcnt vmcnt(8)
    s_cmp_gt_u32 s94, 7
    s_cbranch_scc1 L_lad32
    s_waitcnt vmcnt(7)
    s_cmp_gt_u32 s94, 6
    s_cbranch_scc1 L_lad32
    s_waitcnt vmcnt(6)
    s_cmp_gt_u32 s94, 5
    s_cbranch_scc1 L_lad32
L_low32:
    s_waitcnt vmcnt(5)
    s_cmp_gt_u32 s94, 4
    s_cbranch_scc1 L_lad32
    s_waitcnt vmcnt(4)
    s_cmp_gt_u32 s94, 3
    s_cbranch_scc1 L_lad32
    s_waitcnt vmcnt(3)
L_lad32:
    buffer_load_dwordx4 v[120:123], v1, s[36:39], s76 offen offset:0 nt
    buffer_load_dwordx4 v[124:127], v1, s[36:39], s76 offen offset:256 nt
    s_or_b32 s76, s76, s100
    s_addk_i32 s76, 8192
    s_and_b32 s76, s76, s70
    v_add_u32 v58, 1, v58
    ds_write_b32 v59, v58
    s_add_u32 s77, s77, 2
    s_cmp_lt_u32 s77, 14
    s_cbranch_scc1 L_v
L_v_x:
    s_mov_b32 vcc_lo, 0
    s_mov_b32 vcc_hi, -1
    s_waitcnt vmcnt(15)
    v_and_b32_dpp v34, v30, v2 row_newbcast:0 row_mask:0xf bank_mask:0xf
    v_and_b32_dpp v35, v30, v3 row_newbcast:0 row_mask:0xf bank_mask:0xf
    v_and_b32_dpp v36, v30, v4 row_newbcast:0 row_mask:0xf bank_mask:0xf
    v_and_b32_dpp v37, v30, v5 row_newbcast:0 row_mask:0xf bank_mask:0xf
    s_nop 1
    v_mfma_f32_16x16x32_bf16 v[38:41], v[34:37], v[64:67], v[38:41]
    s_waitcnt vmcnt(14)
    v_mfma_f32_16x16x32_bf16 v[42:45], v[34:37], v[68:71], v[42:45]
    s_waitcnt vmcnt(13)
    v_and_b32_dpp v34, v30, v2 row_newbcast:8 row_mask:0xf bank_mask:0xf
    v_and_b32_dpp v35, v30, v3 row_newbcast:8 row_mask:0xf bank_mask:0xf
    v_and_b32_dpp v36, v30, v4 row_newbcast:8 row_mask:0xf bank_mask:0xf
    v_and_b32_dpp v37, v30, v5 row_newbcast:8 row_mask:0xf bank_mask:0xf
    s_nop 1
    v_mfma_f32_16x16x32_bf16 v[38:41], v[34:37], v[72:75], v[38:41]
    s_waitcnt vmcnt(12)
    v_mfma_f32_16x16x32_bf16 v[42:45], v[34:37], v[76:79], v[42:45]
    s_waitcnt vmcnt(11)
    v_and_b32_dpp v34, v30, v2 row_newbcast:4 row_mask:0xf bank_mask:0xf
    v_and_b32_dpp v35, v30, v3 row_newbcast:4 row_mask:0xf bank_mask:0xf
    v_and_b32_dpp v36, v30, v4 row_newbcast:4 row_mask:0xf bank_mask:0xf
    v_and_b32_dpp v37, v30, v5 row_newbcast:4 row_mask:0xf bank_mask:0xf
    s_nop 1
    v_mfma_f32_16x16x32_bf16 v[38:41], v[34:37], v[80:83], v[38:41]
    s_waitcnt vmcnt(10)
    v_mfma_f32_16x16x32_bf16 v[42:45], v[34:37], v[84:87], v[42:45]
    s_waitcnt vmcnt(9)
    v_and_b32_dpp v34, v30, v2 row_newbcast:12 row_mask:0xf bank_mask:0xf
    v_and_b32_dpp v35, v30, v3 row_newbcast:12 row_mask:0xf bank_mask:0xf
    v_and_b32_dpp v36, v30, v4 row_newbcast:12 row_mask:0xf bank_mask:0xf
    v_and_b32_dpp v37, v30, v5 row_newbcast:12 row_mask:0xf bank_mask:0xf
    s_nop 1
    v_mfma_f32_16x16x32_bf16 v[38:41], v[34:37], v[88:91], v[38:41]
    s_waitcnt vmcnt(8)
    v_mfma_f32_16x16x32_bf16 v[42:45], v[34:37], v[92:95], v[42:45]
    v_mov_b32_dpp v52, v30 quad_perm:[1,2,3,0] row_mask:0xf bank_mask:0xf
    v_mov_b32 v30, v31
    v_mov_b32 v31, v32
    v_mov_b32 v32, v33
    v_mov_b32 v33, v52
    s_waitcnt vmcnt(7)
    v_and_b32_dpp v34, v30, v2 row_newbcast:0 row_mask:0xf bank_mask:0xf
    v_and_b32_dpp v35, v30, v3 row_newbcast:0 row_mask:0xf bank_mask:0xf
    v_and_b32_dpp v36, v30, v4 row_newbcast:0 row_mask:0xf bank_mask:0xf
    v_and_b32_dpp v37, v30, v5 row_newbcast:0 row_mask:0xf bank_mask:0xf
    s_nop 1
    v_mfma_f32_16x16x32_bf16 v[38:41], v[34:37], v[96:99], v[38:41]
    s_waitcnt vmcnt(6)
    v_mfma_f32_16x16x32_bf16 v[42:45], v[34:37], v[100:103], v[42:45]
    s_waitcnt vmcnt(5)
    s_add_u32 m0, s64, 0
    s_add_u32 s78, s86, 0
    buffer_load_dwordx4 v183, s[48:51], s78 offen nt lds
    v_and_b32_dpp v34, v30, v2 row_newbcast:8 row_mask:0xf bank_mask:0xf
    v_and_b32_dpp v35, v30, v3 row_newbcast:8 row_mask:0xf bank_mask:0xf
    v_and_b32_dpp v36, v30, v4 row_newbcast:8 row_mask:0xf bank_mask:0xf
    v_and_b32_dpp v37, v30, v5 row_newbcast:8 row_mask:0xf bank_mask:0xf
    s_nop 1
    v_mfma_f32_16x16x32_bf16 v[38:41], v[34:37], v[104:107], v[38:41]
    s_waitcnt vmcnt(5)
    s_add_u32 m0, s64, 1024
    s_add_u32 s78, s86, 7168
    buffer_load_dwordx4 v185, s[48:51], s78 offen nt lds
    v_mfma_f32_16x16x32_bf16 v[42:45], v[34:37], v[108:111], v[42:45]
    s_waitcnt vmcnt(5)
    s_add_u32 m0, s64, 2048
    s_add_u32 s78, s86, 14336
    buffer_load_dwordx4 v183, s[48:51], s78 offen nt lds
    v_and_b32_dpp v34, v30, v2 row_newbcast:4 row_mask:0xf bank_mask:0xf
    v_and_b32_dpp v35, v30, v3 row_newbcast:4 row_mask:0xf bank_mask:0xf
    v_and_b32_dpp v36, v30, v4 row_newbcast:4 row_mask:0xf bank_mask:0xf
    v_and_b32_dpp v37, v30, v5 row_newbcast:4 row_mask:0xf bank_mask:0xf
    s_nop 1
    v_mfma_f32_16x16x32_bf16 v[38:41], v[34:37], v[112:115], v[38:41]
    s_waitcnt vmcnt(5)
    s_add_u32 m0, s64, 3072
    s_add_u32 s78, s86, 21504
    buffer_load_dwordx4 v185, s[48:51], s78 offen nt lds
    v_mfma_f32_16x16x32_bf16 v[42:45], v[34:37], v[116:119], v[42:45]
    s_waitcnt vmcnt(5)
    s_add_u32 m0, s64, 16384
    s_add_u32 s78, s69, 0
    buffer_load_dwordx4 v183, s[52:55], s78 offen nt lds
    v_and_b32_dpp v34, v30, v2 row_newbcast:12 row_mask:0xf bank_mask:0xf
    v_and_b32_dpp v35, v30, v3 row_newbcast:12 row_mask:0xf bank_mask:0xf
    v_and_b32_dpp v36, v30, v4 row_newbcast:12 row_mask:0xf bank_mask:0xf
    v_and_b32_dpp v37, v30, v5 row_newbcast:12 row_mask:0xf bank_mask:0xf
    s_nop 1
    v_mfma_f32_16x16x32_bf16 v[38:41], v[34:37], v[120:123], v[38:41]
    s_waitcnt vmcnt(5)
    s_add_u32 m0, s64, 17408
    s_add_u32 s78, s69, 7168
    buffer_load_dwordx4 v185, s[52:55], s78 offen nt lds
    v_mfma_f32_16x16x32_bf16 v[42:45], v[34:37], v[124:127], v[42:45]
    s_nop 7
    v_cndmask_b32 v38, v38, v42, vcc
    v_cndmask_b32 v39, v39, v43, vcc
    v_cndmask_b32 v40, v40, v44, vcc
    v_cndmask_b32 v41, v41, v45, vcc
    ds_write_b128 v179, v[38:41] offset:8192
    s_add_u32 m0, s64, 18432
    s_add_u32 s78, s69, 14336
    buffer_load_dwordx4 v183, s[52:55], s78 offen nt lds
    s_add_u32 m0, s64, 19456
    s_add_u32 s78, s69, 21504
    buffer_load_dwordx4 v185, s[52:55], s78 offen nt lds
    s_waitcnt lgkmcnt(0)
    s_barrier
    ds_read_b128 v[96:99], v176 offset:32768
    ds_read_b128 v[100:103], v176 offset:33792
    ds_read_b128 v[104:107], v176 offset:34816
    ds_read_b128 v[108:111], v176 offset:35840
    s_barrier
    buffer_load_dwordx4 v[160:163], v176, s[60:63], s84 offen offset:0 sc1 nt
    buffer_load_dwordx4 v[164:167], v176, s[60:63], s84 offen offset:1024 sc1 nt
    buffer_load_dwordx4 v[168:171], v176, s[60:63], s84 offen offset:2048 sc1 nt
    buffer_load_dwordx4 v[172:175], v176, s[60:63], s84 offen offset:3072 sc1 nt
    s_waitcnt vmcnt(4)
    s_barrier
    s_cmp_ge_u32 s73, 28
    s_cbranch_scc1 L_s_fin
    s_waitcnt lgkmcnt(0)
    ds_read_b64_tr_b16 v[112:113], v178 offset:16384
    ds_read_b64_tr_b16 v[114:115], v178 offset:16896
    ds_read_b64_tr_b16 v[116:117], v178 offset:20480
    ds_read_b64_tr_b16 v[118:119], v178 offset:20992
    ds_read_b64_tr_b16 v[120:121], v178 offset:24576
    ds_read_b64_tr_b16 v[122:123], v178 offset:25088
    ds_read_b64_tr_b16 v[124:125], v178 offset:28672
    ds_read_b64_tr_b16 v[126:127], v178 offset:29184
    ds_read_b64_tr_b16 v[144:145], v178 offset:0
    ds_read_b64_tr_b16 v[146:147], v178 offset:512
    ds_read_b64_tr_b16 v[148:149], v178 offset:4096
    ds_read_b64_tr_b16 v[150:151], v178 offset:4608
    ds_read_b64_tr_b16 v[152:153], v178 offset:8192
    ds_read_b64_tr_b16 v[154:155], v178 offset:8704
    s_waitcnt lgkmcnt(6)
    ds_read_b64_tr_b16 v[156:157], v178 offset:12288
    ds_read_b64_tr_b16 v[158:159], v178 offset:12800
    v_mfma_f32_16x16x32_bf16 v[42:45], v[96:99], v[112:115], 0
    v_mfma_f32_16x16x32_bf16 v[42:45], v[100:103], v[116:119], v[42:45]
    v_mfma_f32_16x16x32_bf16 v[42:45], v[104:107], v[120:123], v[42:45]
    v_mfma_f32_16x16x32_bf16 v[42:45], v[108:111], v[124:127], v[42:45]
    s_waitcnt vmcnt(0)
    s_mov_b32 s88, 524288
    s_branch L_s2_chk
L_s2:
    buffer_load_dwordx4 v[160:163], v176, s[60:63], s84 offen offset:0 sc1 nt
    buffer_load_dwordx4 v[164:167], v176, s[60:63], s84 offen offset:1024 sc1 nt
    buffer_load_dwordx4 v[168:171], v176, s[60:63], s84 offen offset:2048 sc1 nt
    buffer_load_dwordx4 v[172:175], v176, s[60:63], s84 offen offset:3072 sc1 nt
    s_sub_u32 s88, s88, 1
    s_cmp_eq_u32 s88, 0
    s_waitcnt vmcnt(0) lgkmcnt(0)
    s_cbranch_scc1 L_s2_go
L_s2_chk:
    v_max_u32 v54, v160, v161
    v_max_u32 v56, v162, v163
    v_max3_u32 v54, v54, v164, v165
    v_max3_u32 v56, v56, v166, v167
    v_max3_u32 v54, v54, v168, v169
    v_max3_u32 v56, v56, v170, v171
    v_max3_u32 v54, v54, v172, v173
    v_max3_u32 v56, v56, v174, v175
    v_max_u32 v54, v54, v56
    v_cmp_eq_u32 vcc, -1, v54
    s_nop 0
    s_and_b64 exec, exec, vcc
    s_cbranch_scc1 L_s2
L_s2_go:
    s_mov_b64 exec, -1
    s_waitcnt lgkmcnt(0)
    v_mfma_f32_16x16x32_bf16 v[38:41], v[160:163], v[144:147], 0
    v_mfma_f32_16x16x32_bf16 v[38:41], v[164:167], v[148:151], v[38:41]
    v_mfma_f32_16x16x32_bf16 v[38:41], v[168:171], v[152:155], v[38:41]
    v_mfma_f32_16x16x32_bf16 v[38:41], v[172:175], v[156:159], v[38:41]
    v_add_u32 v42, 0x800, v42
    v_and_or_b32 v42, v42, v206, v207
    buffer_store_dword v42, v184, s[60:63], s85 offen sc1
    s_nop 4
    v_add_f32 v38, v38, v39
    v_add_f32 v40, v40, v41
    v_add_f32 v38, v38, v40
    v_add_u32 v38, 0x800, v38
    v_and_or_b32 v38, v38, v206, v207
    buffer_store_dword v38, v177, s[60:63], s85 offen sc1
L_s_fin:
    s_waitcnt vmcnt(0)
    s_barrier
    s_endpgm
L_gov:
    v_lshlrev_b32 v16, 4, v0
    s_lshl_b32 s79, s72, 5
    s_add_u32 s79, s79, s73
    s_lshl_b32 s79, s79, 7
    s_add_u32 s79, s79, 819200
    s_mov_b32 s62, 1966080
    s_mov_b32 s63, 0x20000
    s_waitcnt lgkmcnt(0)
    s_load_dwordx2 s[56:57], s[28:29], 933888
    s_mov_b32 s60, s28
    s_mov_b32 s61, s29
    s_mov_b64 exec, 0xff
    s_waitcnt lgkmcnt(0)
    s_add_u32 s56, s56, 2654435769
    s_addc_u32 s57, s57, 2135587861
    s_lshr_b32 s58, s57, 4
    s_getreg_b32 s78, hwreg(HW_REG_XCC_ID, 0, 4)
    s_lshl_b32 s59, s58, 4
    s_or_b32 s59, s59, s78
    v_mov_b32 v8, s56
    v_mov_b32 v9, s59
    v_mov_b32 v10, s56
    v_mov_b32 v11, s59
    buffer_store_dwordx4 v[8:11], v16, s[60:63], s79 offen sc1
    s_mov_b64 exec, -1
    s_and_b32 s65, s56, 0xfff
    s_bfe_u32 s66, s56, 0xc000c
    s_and_b32 s67, s58, 0xfff
    s_bfe_u32 s68, s58, 0xc000c
    s_mul_i32 s85, s72, 114688
    s_add_u32 s85, s85, 1048576
    s_cmp_lg_u32 s73, 0
    s_cbranch_scc1 L_norace
    s_lshl_b32 s79, s72, 7
    s_add_u32 s79, s79, 950272
    s_add_u32 s80, s79, 8192
    s_mov_b64 exec, 0xff
    buffer_store_dwordx4 v[8:11], v16, s[60:63], s79 offen sc1
    buffer_store_dwordx4 v[8:11], v16, s[60:63], s80 offen sc1
    s_mov_b64 exec, -1
    s_add_u32 s4, s28, s79
    s_addc_u32 s5, s29, 0
    s_mov_b32 s79, 0
    s_waitcnt vmcnt(0)
    s_not_b32 s10, s56
    s_not_b32 s11, s56
    s_load_dword s10, s[4:5], 0 glc
    s_load_dword s11, s[4:5], 8192 glc
    s_waitcnt lgkmcnt(1)
    s_sleep 1
    s_mov_b64 s[14:15], s[10:11]
    s_waitcnt lgkmcnt(0)
    s_cmp_eq_u32 s15, s56
    s_addc_u32 s79, s79, 0
    s_cmp_eq_u32 s14, s56
    s_subb_u32 s79, s79, 0
    s_not_b32 s10, s56
    s_not_b32 s11, s56
    s_load_dword s11, s[4:5], 8192 glc
    s_load_dword s10, s[4:5], 0 glc
    s_waitcnt lgkmcnt(1)
    s_sleep 1
    s_mov_b64 s[14:15], s[10:11]
    s_waitcnt lgkmcnt(0)
    s_cmp_eq_u32 s15, s56
    s_addc_u32 s79, s79, 0
    s_cmp_eq_u32 s14, s56
    s_subb_u32 s79, s79, 0
    s_not_b32 s10, s56
    s_not_b32 s11, s56
    s_load_dword s10, s[4:5], 0 glc
    s_load_dword s11, s[4:5], 8192 glc
    s_waitcnt lgkmcnt(1)
    s_sleep 1
    s_mov_b64 s[14:15], s[10:11]
    s_waitcnt lgkmcnt(0)
    s_cmp_eq_u32 s15, s56
    s_addc_u32 s79, s79, 0
    s_cmp_eq_u32 s14, s56
    s_subb_u32 s79, s79, 0
    s_not_b32 s10, s56
    s_not_b32 s11, s56
    s_load_dword s11, s[4:5], 8192 glc
    s_load_dword s10, s[4:5], 0 glc
    s_waitcnt lgkmcnt(1)
    s_sleep 1
    s_mov_b64 s[14:15], s[10:11]
    s_waitcnt lgkmcnt(0)
    s_cmp_eq_u32 s15, s56
    s_addc_u32 s79, s79, 0
    s_cmp_eq_u32 s14, s56
    s_subb_u32 s79, s79, 0
    s_sub_i32 s80, 0, s79
    s_bitcmp1_b32 s59, 2
    s_cselect_b32 s79, s80, s79
    s_cmp_gt_i32 s79, 0
    s_cselect_b32 s80, 2, 0
    s_cmp_lt_i32 s79, 0
    s_cselect_b32 s80, 1, s80
    s_and_b32 s79, s59, 4
    s_or_b32 s79, s79, s80
    s_lshl4_add_u32 s79, s58, s79
    v_mov_b32 v12, s56
    v_mov_b32 v13, s79
    v_mov_b32 v14, s56
    v_mov_b32 v15, s79
    s_lshl_b32 s79, s72, 7
    s_add_u32 s79, s79, 937984
    s_mov_b64 exec, 0xff
    buffer_store_dwordx4 v[12:15], v16, s[60:63], s79 offen sc1
    s_mov_b64 exec, -1
L_norace:
    s_lshr_b32 s78, s73, 2
    s_lshl_b32 s78, s78, 14
    s_add_u32 s85, s85, s78
    s_and_b32 s78, s73, 3
    s_lshl_b32 s78, s78, 11
    s_add_u32 s85, s85, s78
    s_mov_b32 s44, s24
    s_mov_b32 s45, s25
    s_mov_b32 s46, 7168
    s_mov_b32 s47, 0x20000
    v_and_b32 v2, 3, v0
    v_lshlrev_b32 v2, 2, v2
    v_mov_b32 v6, 0
    v_mov_b32 v8, 4
    v_mov_b32 v7, 0
    ds_write_b32 v2, v6 offset:46608
    ds_write_b32 v2, v8 offset:46624
    s_mul_i32 s84, s72, 4352
    s_add_u32 s84, s84, 851968
    v_lshlrev_b32 v3, 2, v0
    s_lshl2_add_u32 s76, s73, s84
    s_add_u32 s83, s84, 34816
    s_mul_i32 s86, s72, 192
    s_add_u32 s86, s86, 192
    s_cmp_eq_u32 s73, 28
    s_cselect_b32 s86, s86, -1
    s_and_b32 s78, s72, 3
    s_mul_i32 s87, s78, 1792
    s_lshr_b32 s78, s72, 2
    s_mul_i32 s78, s78, 896
    s_add_u32 s87, s87, s78
    s_lshl_b32 s78, s73, 5
    s_add_u32 s87, s87, s78
    v_lshrrev_b32 v55, 1, v60
    v_and_b32 v56, 1, v60
    v_lshl_add_u32 v55, v56, 1, v55
    v_and_b32 v56, 3, v61
    v_lshl_add_u32 v55, v56, 2, v55
    v_lshlrev_b32 v57, 1, v55
    s_waitcnt lgkmcnt(0)
    s_barrier
    ds_read_b32 v10, v7 offset:46596
    ds_read_b32 v11, v7 offset:46600
    s_waitcnt lgkmcnt(0)
    v_readfirstlane_b32 s89, v10
    v_readfirstlane_b32 s71, v11
    s_nop 0
    s_lshr_b32 s78, s71, s72
    s_and_b32 s78, s78, 1
    s_lshl_b32 s78, s78, 13
    s_add_u32 s85, s85, s78
    s_cmp_lg_u32 s89, 1
    s_cbranch_scc1 L_gend
    s_mov_b32 s88, 524288
L_g0:
    s_sleep 4
    ds_read_b32 v4, v2 offset:46608
    s_sub_u32 s88, s88, 1
    s_cmp_eq_u32 s88, 0
    s_waitcnt vmcnt(0) lgkmcnt(0)
    s_cbranch_scc1 L_g0_go
    v_cmp_eq_u32 vcc, 0, v4
    s_nop 0
    s_cbranch_vccnz L_g0
L_g0_go:
    s_add_u32 s78, s72, 1
    s_and_b32 s78, s78, 7
    s_mul_i32 s32, s78, 4352
    s_add_u32 s32, s32, 886784
    s_mul_i32 s48, s78, 192
    s_sub_u32 s48, s48, 1344
    s_add_u32 s78, s72, 2
    s_and_b32 s78, s78, 7
    s_mul_i32 s33, s78, 4352
    s_add_u32 s33, s33, 886784
    s_mul_i32 s49, s78, 192
    s_sub_u32 s49, s49, 1344
    s_add_u32 s78, s72, 3
    s_and_b32 s78, s78, 7
    s_mul_i32 s34, s78, 4352
    s_add_u32 s34, s34, 886784
    s_mul_i32 s50, s78, 192
    s_sub_u32 s50, s50, 1344
    s_add_u32 s78, s72, 4
    s_and_b32 s78, s78, 7
    s_mul_i32 s35, s78, 4352
    s_add_u32 s35, s35, 886784
    s_mul_i32 s51, s78, 192
    s_sub_u32 s51, s51, 1344
    s_add_u32 s78, s72, 5
    s_and_b32 s78, s78, 7
    s_mul_i32 s36, s78, 4352
    s_add_u32 s36, s36, 886784
    s_mul_i32 s52, s78, 192
    s_sub_u32 s52, s52, 1344
    s_add_u32 s78, s72, 6
    s_and_b32 s78, s78, 7
    s_mul_i32 s37, s78, 4352
    s_add_u32 s37, s37, 886784
    s_mul_i32 s53, s78, 192
    s_sub_u32 s53, s53, 1344
    s_add_u32 s78, s72, 7
    s_and_b32 s78, s78, 7
    s_mul_i32 s38, s78, 4352
    s_add_u32 s38, s38, 886784
    s_mul_i32 s54, s78, 192
    s_sub_u32 s54, s54, 1344
    s_sub_u32 s82, s86, 1536
    s_mov_b32 s40, 0x3fff
    s_mov_b32 s41, 0xffff
    s_mov_b32 s42, 0x8000
    s_mov_b32 s88, 524288
L_gloop:
    ds_read_b32 v4, v2 offset:46608
    s_sub_u32 s88, s88, 1
    s_cmp_eq_u32 s88, 0
    s_cbranch_scc1 L_gend
    s_waitcnt lgkmcnt(0)
    v_add_u32_dpp v5, v4, v4 quad_perm:[1,0,3,2] row_mask:0xf bank_mask:0xf
    s_nop 1
    v_add_u32_dpp v5, v5, v5 quad_perm:[2,3,0,1] row_mask:0xf bank_mask:0xf
    s_mov_b64 exec, 1
    buffer_store_dword v5, off, s[60:63], s76
    v_cmp_le_u32 vcc, 404, v5
    s_nop 0
    s_cbranch_vccnz L_gend
    s_mov_b32 exec_lo, -1
    s_mov_b32 exec_hi, 1
    buffer_load_dword v7, v3, s[60:63], s84 offen sc1 nt
    s_mov_b64 exec, -1
    s_cmp_eq_u32 s86, -1
    s_cbranch_scc1 L_gnl
    s_load_dwordx2 s[6:7], s[28:29], s32 glc
    s_load_dwordx2 s[8:9], s[28:29], s33 glc
    s_load_dwordx2 s[10:11], s[28:29], s34 glc
    s_load_dwordx2 s[12:13], s[28:29], s35 glc
    s_load_dwordx2 s[14:15], s[28:29], s36 glc
    s_load_dwordx2 s[16:17], s[28:29], s37 glc
    s_load_dwordx2 s[18:19], s[28:29], s38 glc
L_gnl:
    v_cvt_f32_u32 v54, v5
    v_mul_f32 v54, 3187671040, v54
    v_add_f32 v54, 1085066445, v54
    v_lshlrev_b32 v4, 2, v4
    v_sub_u32 v4, v5, v4
    v_cvt_f32_i32 v4, v4
    v_mul_f32 v4, 1034147594, v4
    v_add_f32 v54, v54, v4
    s_waitcnt vmcnt(0)
    v_add_u32_dpp v55, v7, v7 row_ror:8 row_mask:0xf bank_mask:0xf
    v_readlane_b32 s81, v7, 32
    s_nop 0
    v_add_u32_dpp v55, v55, v55 row_ror:4 row_mask:0xf bank_mask:0xf
    s_nop 1
    v_add_u32_dpp v55, v55, v55 row_ror:2 row_mask:0xf bank_mask:0xf
    s_nop 1
    v_add_u32_dpp v55, v55, v55 row_ror:1 row_mask:0xf bank_mask:0xf
    s_nop 0
    v_readlane_b32 s78, v55, 0
    v_readlane_b32 s79, v55, 16
    v_cvt_f32_i32 v11, s81
    s_add_u32 s80, s78, s79
    v_cvt_f32_u32 v10, s80
    v_mul_f32 v10, 998244352, v10
    v_mul_f32 v11, 968884224, v11
    v_add_f32 v54, v54, v10
    v_add_f32 v54, v54, v11
    v_add_f32 v10, 3234122957, v54
    v_max_f32 v10, 0, v10
    v_mul_f32 v10, 1073741824, v10
    v_add_f32 v54, v54, v10
    v_cvt_i32_f32 v8, v54
    v_med3_i32 v8, v8, 3, 12
    ds_write_b32 v2, v8 offset:46624
    s_cmp_eq_u32 s86, -1
    s_cbranch_scc1 L_gloop
    s_sub_u32 s78, 1130, s80
    s_lshl3_add_u32 s78, s78, s82
    s_waitcnt lgkmcnt(0)
    s_xor_b64 s[6:7], s[6:7], s[56:57]
    s_andn2_b64 s[4:5], s[6:7], s[40:41]
    s_cselect_b32 s7, s42, s7
    s_cselect_b32 s6, s48, s6
    s_add_u32 s78, s78, s6
    s_xor_b64 s[8:9], s[8:9], s[56:57]
    s_andn2_b64 s[4:5], s[8:9], s[40:41]
    s_cselect_b32 s9, s42, s9
    s_cselect_b32 s8, s49, s8
    s_add_u32 s78, s78, s8
    s_xor_b64 s[10:11], s[10:11], s[56:57]
    s_andn2_b64 s[4:5], s[10:11], s[40:41]
    s_cselect_b32 s11, s42, s11
    s_cselect_b32 s10, s50, s10
    s_add_u32 s78, s78, s10
    s_xor_b64 s[12:13], s[12:13], s[56:57]
    s_andn2_b64 s[4:5], s[12:13], s[40:41]
    s_cselect_b32 s13, s42, s13
    s_cselect_b32 s12, s51, s12
    s_add_u32 s78, s78, s12
    s_xor_b64 s[14:15], s[14:15], s[56:57]
    s_andn2_b64 s[4:5], s[14:15], s[40:41]
    s_cselect_b32 s15, s42, s15
    s_cselect_b32 s14, s52, s14
    s_add_u32 s78, s78, s14
    s_xor_b64 s[16:17], s[16:17], s[56:57]
    s_andn2_b64 s[4:5], s[16:17], s[40:41]
    s_cselect_b32 s17, s42, s17
    s_cselect_b32 s16, s53, s16
    s_add_u32 s78, s78, s16
    s_xor_b64 s[18:19], s[18:19], s[56:57]
    s_andn2_b64 s[4:5], s[18:19], s[40:41]
    s_cselect_b32 s19, s42, s19
    s_cselect_b32 s18, s54, s18
    s_add_u32 s78, s78, s18
    s_add_i32 s43, s78, 0x8000
    s_max_i32 s43, s43, 0
    s_min_i32 s43, s43, 0xffff
    s_mov_b32 s4, s42
    s_mov_b32 s5, s42
    s_max_u32 s4, s4, s7
    s_add_u32 s5, s5, s7
    s_max_u32 s4, s4, s9
    s_add_u32 s5, s5, s9
    s_max_u32 s4, s4, s11
    s_add_u32 s5, s5, s11
    s_max_u32 s4, s4, s13
    s_add_u32 s5, s5, s13
    s_max_u32 s4, s4, s15
    s_add_u32 s5, s5, s15
    s_max_u32 s4, s4, s17
    s_add_u32 s5, s5, s17
    s_max_u32 s4, s4, s19
    s_add_u32 s5, s5, s19
    s_lshr_b32 s5, s5, 3
    s_sub_i32 s4, s4, s5
    s_sub_i32 s4, s4, 600
    s_max_i32 s4, s4, 0
    s_mul_i32 s4, s4, 8
    s_lshr_b32 s4, s4, 4
    s_sub_i32 s78, s78, s4
    v_mov_b32 v10, s78
    s_mov_b64 exec, 1
    buffer_store_dword v10, off, s[60:63], s84 offset:128
    s_mov_b64 exec, -1
    s_cmp_lt_u32 s80, s86
    s_cbranch_scc1 L_gloop
    s_xor_b32 s78, s80, s56
    s_mov_b32 s42, s43
    s_xor_b32 s79, s43, s57
    v_mov_b32 v12, s78
    v_mov_b32 v13, s79
    v_mov_b32 v14, s78
    v_mov_b32 v15, s79
    s_mov_b64 exec, 0xff
    buffer_store_dwordx4 v[12:15], v16, s[60:63], s83 offen sc1
    s_mov_b64 exec, -1
    s_add_u32 s86, s86, 1536
    s_mov_b32 s82, s80
    s_branch L_gloop
L_gend:
    s_mov_b64 exec, -1
    s_cmp_ge_u32 s73, 28
    s_barrier
    s_barrier
    s_barrier
    s_barrier
    s_cbranch_scc1 L_g_fin
    s_mov_b32 s88, 524288
L_f:
    buffer_load_dwordx4 v[64:67], v16, s[60:63], s85 offen offset:0 sc1
    buffer_load_dwordx4 v[68:71], v16, s[60:63], s85 offen offset:1024 sc1
    s_sub_u32 s88, s88, 1
    s_cmp_eq_u32 s88, 0
    s_waitcnt vmcnt(0) lgkmcnt(0)
    s_cbranch_scc1 L_f_go
    v_xor_b32 v64, s65, v64
    v_xor_b32 v65, s66, v65
    v_xor_b32 v66, s67, v66
    v_xor_b32 v67, s68, v67
    v_xor_b32 v68, s65, v68
    v_xor_b32 v69, s66, v69
    v_xor_b32 v70, s67, v70
    v_xor_b32 v71, s68, v71
    v_or3_b32 v54, v64, v65, v66
    v_or3_b32 v56, v67, v68, v69
    v_or3_b32 v54, v54, v70, v71
    v_or_b32 v54, v54, v56
    v_and_b32 v54, 0xfff, v54
    v_cmp_ne_u32 vcc, 0, v54
    s_nop 0
    s_and_b64 exec, exec, vcc
    s_cbranch_scc1 L_f
L_f_go:
    s_mov_b64 exec, -1
    v_add_f32 v64, v64, v68
    v_add_f32 v65, v65, v69
    v_add_f32 v66, v66, v70
    v_add_f32 v67, v67, v71
    v_permlane32_swap_b32 v64, v65
    s_nop 0
    v_permlane32_swap_b32 v66, v67
    v_add_f32 v64, v64, v65
    v_add_f32 v66, v66, v67
    s_nop 1
    v_permlane16_swap_b32 v64, v66
    v_add_f32 v64, v64, v66
    s_nop 1
    v_add_f32_dpp v64, v64, v64 row_ror:4 row_mask:0xf bank_mask:0xf
    s_nop 1
    v_add_f32_dpp v64, v64, v64 row_ror:8 row_mask:0xf bank_mask:0xf
    v_cvt_pk_bf16_f32 v64, v64, v64
    s_mov_b32 exec_lo, 0x000f000f
    s_mov_b32 exec_hi, 0x000f000f
    buffer_store_short v64, v57, s[44:47], s87 offen
    s_cmp_eq_u32 s2, 0
    s_cbranch_scc0 L_g_fin
    v_mov_b32 v8, s56
    v_mov_b32 v9, s57
    s_mov_b32 s78, 933888
    s_mov_b64 exec, 1
    buffer_store_dwordx2 v[8:9], off, s[60:63], s78 sc1
L_g_fin:
    s_endpgm
L_helper:
    s_cmp_eq_u32 s3, 5
    s_cbranch_scc1 L_gov
    s_getpc_b64 s[30:31]
L_pc:
    s_sub_u32 s30, s30, L_pc-concat_heads__mha_block_cached__sliding_block_cached__decode_kernel
    s_subb_u32 s31, s31, 0
    s_lshl_b32 s79, s73, 6
    v_lshl_add_u32 v54, v0, 11, s79
    v_min_u32 v54, L_end-concat_heads__mha_block_cached__sliding_block_cached__decode_kernel, v54
    s_mov_b64 exec, 4095
    global_load_dword v2, v54, s[30:31]
    s_mov_b64 exec, -1
    v_lshrrev_b32 v57, 3, v0
    v_and_b32 v56, 7, v0
    v_lshlrev_b32 v56, 4, v56
    v_lshl_add_u32 v1, v57, 13, v56
    v_and_b32 v5, 3, v0
    v_mul_u32_u24 v5, 896, v5
    v_lshl_add_u32 v5, v60, 4, v5
    s_bfe_u32 s44, s73, 0x10003
    s_add_u32 s45, s73, 0
    s_and_b32 s45, s45, 7
    s_lshl3_add_u32 s45, s72, s45
    s_mul_i32 s46, s78, 0
    s_xor_b32 s47, s45, s46
    s_mul_i32 s46, s44, 1835008
    s_lshl_b32 s47, s47, 7
    s_add_u32 s76, s46, s47
    s_mul_i32 s80, s44, 448
    s_mov_b32 s34, 3670016
    s_mov_b32 s35, 0x20000
    s_mov_b32 s38, 3584
    s_mov_b32 s39, 0x20000
    s_mov_b32 m0, 0
    s_cmp_eq_u32 s78, 0
    s_waitcnt lgkmcnt(0)
    s_cselect_b32 s32, s10, s20
    s_cselect_b32 s33, s11, s21
    s_cselect_b32 s36, s4, s14
    s_cselect_b32 s37, s5, s15
    s_load_dwordx2 s[56:57], s[28:29], 933888
    s_mul_i32 s40, s44, 5
    s_mul_i32 s41, s78, 3
    s_add_u32 s40, s40, s41
    s_cmp_ge_u32 s40, 7
    s_cselect_b32 s41, 7, 0
    s_sub_u32 s40, s40, s41
    s_lshl_b32 s41, s40, 18
    s_add_u32 s76, s76, s41
    s_lshl_b32 s41, s40, 6
    s_add_u32 s80, s80, s41
    buffer_load_dwordx4 v[64:67], v5, s[36:39], s80 offen offset:0
    buffer_load_dwordx4 v1, s[32:35], s76 offen nt lds
    s_add_u32 m0, m0, 1024
    s_add_u32 s76, s76, 65536
    buffer_load_dwordx4 v1, s[32:35], s76 offen nt lds
    s_add_u32 m0, m0, 1024
    s_add_u32 s76, s76, 65536
    buffer_load_dwordx4 v1, s[32:35], s76 offen nt lds
    s_add_u32 m0, m0, 1024
    s_add_u32 s76, s76, 65536
    buffer_load_dwordx4 v1, s[32:35], s76 offen nt lds
    s_add_u32 m0, m0, 1024
    s_add_u32 s76, s76, 65536
    s_cmp_eq_u32 s40, 6
    s_cselect_b32 s41, 1835008, 0
    s_cselect_b32 s42, -384, 64
    s_sub_u32 s76, s76, s41
    s_add_i32 s80, s80, s42
    buffer_load_dwordx4 v[68:71], v5, s[36:39], s80 offen offset:0
    buffer_load_dwordx4 v1, s[32:35], s76 offen nt lds
    s_add_u32 m0, m0, 1024
    s_add_u32 s76, s76, 65536
    buffer_load_dwordx4 v1, s[32:35], s76 offen nt lds
    s_add_u32 m0, m0, 1024
    s_add_u32 s76, s76, 65536
    buffer_load_dwordx4 v1, s[32:35], s76 offen nt lds
    s_add_u32 m0, m0, 1024
    s_add_u32 s76, s76, 65536
    buffer_load_dwordx4 v1, s[32:35], s76 offen nt lds
    s_add_u32 m0, m0, 1024
    s_add_u32 s76, s76, 65536
    s_cmp_eq_u32 s40, 5
    s_cselect_b32 s41, 1835008, 0
    s_cselect_b32 s42, -384, 64
    s_sub_u32 s76, s76, s41
    s_add_i32 s80, s80, s42
    buffer_load_dwordx4 v[72:75], v5, s[36:39], s80 offen offset:0
    buffer_load_dwordx4 v1, s[32:35], s76 offen nt lds
    s_add_u32 m0, m0, 1024
    s_add_u32 s76, s76, 65536
    buffer_load_dwordx4 v1, s[32:35], s76 offen nt lds
    s_add_u32 m0, m0, 1024
    s_add_u32 s76, s76, 65536
    buffer_load_dwordx4 v1, s[32:35], s76 offen nt lds
    s_add_u32 m0, m0, 1024
    s_add_u32 s76, s76, 65536
    buffer_load_dwordx4 v1, s[32:35], s76 offen nt lds
    s_add_u32 m0, m0, 1024
    s_add_u32 s76, s76, 65536
    s_cmp_eq_u32 s40, 4
    s_cselect_b32 s41, 1835008, 0
    s_cselect_b32 s42, -384, 64
    s_sub_u32 s76, s76, s41
    s_add_i32 s80, s80, s42
    buffer_load_dwordx4 v[76:79], v5, s[36:39], s80 offen offset:0
    buffer_load_dwordx4 v1, s[32:35], s76 offen nt lds
    s_add_u32 m0, m0, 1024
    s_add_u32 s76, s76, 65536
    buffer_load_dwordx4 v1, s[32:35], s76 offen nt lds
    s_add_u32 m0, m0, 1024
    s_add_u32 s76, s76, 65536
    buffer_load_dwordx4 v1, s[32:35], s76 offen nt lds
    s_add_u32 m0, m0, 1024
    s_add_u32 s76, s76, 65536
    buffer_load_dwordx4 v1, s[32:35], s76 offen nt lds
    s_add_u32 m0, m0, 1024
    s_add_u32 s76, s76, 65536
    s_cmp_eq_u32 s40, 3
    s_cselect_b32 s41, 1835008, 0
    s_cselect_b32 s42, -384, 64
    s_sub_u32 s76, s76, s41
    s_add_i32 s80, s80, s42
    buffer_load_dwordx4 v[80:83], v5, s[36:39], s80 offen offset:0
    buffer_load_dwordx4 v1, s[32:35], s76 offen nt lds
    s_add_u32 m0, m0, 1024
    s_add_u32 s76, s76, 65536
    buffer_load_dwordx4 v1, s[32:35], s76 offen nt lds
    s_add_u32 m0, m0, 1024
    s_add_u32 s76, s76, 65536
    buffer_load_dwordx4 v1, s[32:35], s76 offen nt lds
    s_add_u32 m0, m0, 1024
    s_add_u32 s76, s76, 65536
    buffer_load_dwordx4 v1, s[32:35], s76 offen nt lds
    s_add_u32 m0, m0, 1024
    s_add_u32 s76, s76, 65536
    s_cmp_eq_u32 s40, 2
    s_cselect_b32 s41, 1835008, 0
    s_cselect_b32 s42, -384, 64
    s_sub_u32 s76, s76, s41
    s_add_i32 s80, s80, s42
    buffer_load_dwordx4 v[84:87], v5, s[36:39], s80 offen offset:0
    buffer_load_dwordx4 v1, s[32:35], s76 offen nt lds
    s_add_u32 m0, m0, 1024
    s_add_u32 s76, s76, 65536
    buffer_load_dwordx4 v1, s[32:35], s76 offen nt lds
    s_add_u32 m0, m0, 1024
    s_add_u32 s76, s76, 65536
    buffer_load_dwordx4 v1, s[32:35], s76 offen nt lds
    s_add_u32 m0, m0, 1024
    s_add_u32 s76, s76, 65536
    buffer_load_dwordx4 v1, s[32:35], s76 offen nt lds
    s_add_u32 m0, m0, 1024
    s_add_u32 s76, s76, 65536
    s_cmp_eq_u32 s40, 1
    s_cselect_b32 s41, 1835008, 0
    s_cselect_b32 s42, -384, 64
    s_sub_u32 s76, s76, s41
    s_add_i32 s80, s80, s42
    buffer_load_dwordx4 v[88:91], v5, s[36:39], s80 offen offset:0
    buffer_load_dwordx4 v1, s[32:35], s76 offen nt lds
    s_add_u32 m0, m0, 1024
    s_add_u32 s76, s76, 65536
    buffer_load_dwordx4 v1, s[32:35], s76 offen nt lds
    s_add_u32 m0, m0, 1024
    s_add_u32 s76, s76, 65536
    buffer_load_dwordx4 v1, s[32:35], s76 offen nt lds
    s_add_u32 m0, m0, 1024
    s_add_u32 s76, s76, 65536
    buffer_load_dwordx4 v1, s[32:35], s76 offen nt lds
    s_lshl1_add_u32 s64, s78, s44
    s_lshl_b32 s64, s64, 16
    s_lshl_b32 s46, s45, 10
    s_add_u32 s64, s64, s46
    s_lshl3_add_u32 s48, s78, s72
    s_and_b32 s81, s73, 15
    s_lshl4_add_u32 s48, s48, s81
    s_lshl_b32 s48, s48, 7
    s_add_u32 s48, s48, 262144
    s_mov_b32 s60, s28
    s_mov_b32 s61, s29
    s_mov_b32 s62, 1966080
    s_mov_b32 s63, 0x20000
    s_mul_i32 s78, s73, 37
    s_lshr_b32 s78, s78, 8
    s_mul_i32 s79, s78, 7
    s_sub_u32 s79, s73, s79
    s_lshl_b32 s80, s72, 2
    s_add_u32 s78, s78, s80
    s_mul_i32 s86, s78, 114688
    s_lshl_b32 s80, s79, 7
    s_add_u32 s86, s86, s80
    s_lshr_b32 s84, s78, 1
    s_lshl_b32 s84, s84, 14
    s_and_b32 s80, s78, 1
    s_lshl_b32 s80, s80, 12
    s_add_u32 s84, s84, s80
    s_add_u32 s84, s84, 557056
    s_lshl_b32 s85, s79, 14
    s_lshl_b32 s80, s78, 6
    s_add_u32 s85, s85, s80
    s_add_u32 s85, s85, 1048576
    v_lshrrev_b32 v54, 2, v61
    v_and_b32 v56, 3, v61
    v_lshlrev_b32 v176, 4, v0
    v_lshl_add_u32 v178, v60, 3, v54
    v_lshlrev_b32 v178, 7, v178
    v_lshl_add_u32 v178, v56, 3, v178
    v_lshrrev_b32 v54, 3, v0
    v_mul_u32_u24 v54, 896, v54
    v_and_b32 v56, 7, v0
    v_lshl_add_u32 v183, v56, 4, v54
    s_lshl_b32 s82, s74, 14
    s_add_u32 s82, s82, 294912
    s_lshl_b32 s83, s72, 15
    s_add_u32 s83, s83, 557056
    s_lshl_b32 s49, s81, 9
    s_add_u32 s49, s49, s82
    s_lshl_b32 s50, s73, 9
    s_add_u32 s50, s50, s83
    v_and_b32 v54, 31, v0
    v_lshlrev_b32 v54, 4, v54
    v_lshrrev_b32 v55, 5, v0
    v_lshl_add_u32 v18, v55, 14, v54
    s_lshl4_add_u32 s82, s81, s82
    s_lshr_b32 s78, s73, 3
    s_and_b32 s79, s73, 3
    s_lshl2_add_u32 s78, s78, s79
    s_lshl4_add_u32 s83, s78, s83
    s_bfe_u32 s78, s73, 0x10002
    s_lshl_b32 s78, s78, 13
    s_add_u32 s83, s83, s78
    v_lshrrev_b32 v54, 1, v0
    v_lshlrev_b32 v54, 8, v54
    v_and_b32 v55, 1, v0
    v_lshl_add_u32 v179, v55, 3, v54
    s_mul_i32 s69, s72, 4352
    s_add_u32 s69, s69, 851968
    s_cmp_eq_u32 s73, 0
    s_cselect_b32 s51, s69, 1073741824
    s_lshl_b32 s70, s72, 12
    s_add_u32 s70, s70, 819200
    v_mov_b32 v34, -1
    v_mov_b32 v35, -1
    v_mov_b32 v36, -1
    v_mov_b32 v37, -1
    v_mov_b32 v38, 0
    v_mov_b32 v39, 0
    v_mov_b32 v40, 0
    v_mov_b32 v41, 0
    v_lshlrev_b32 v16, 4, v0
    v_lshlrev_b32 v7, 3, v0
    v_lshlrev_b32 v57, 7, v0
    v_and_b32 v54, 3, v61
    v_lshlrev_b32 v54, 8, v54
    v_lshrrev_b32 v55, 2, v61
    v_lshl_add_u32 v54, v55, 6, v54
    v_lshl_add_u32 v17, v60, 4, v54
    s_waitcnt vmcnt(30)
    ds_read_b64_tr_b16 v[96:97], v178 offset:0
    ds_read_b64_tr_b16 v[98:99], v178 offset:512
    ds_read_b64_tr_b16 v[100:101], v178 offset:32
    ds_read_b64_tr_b16 v[102:103], v178 offset:544
    ds_read_b64_tr_b16 v[104:105], v178 offset:64
    ds_read_b64_tr_b16 v[106:107], v178 offset:576
    ds_read_b64_tr_b16 v[108:109], v178 offset:96
    ds_read_b64_tr_b16 v[110:111], v178 offset:608
    s_waitcnt vmcnt(25)
    s_waitcnt lgkmcnt(0)
    ds_read_b64_tr_b16 v[112:113], v178 offset:4096
    ds_read_b64_tr_b16 v[114:115], v178 offset:4608
    ds_read_b64_tr_b16 v[116:117], v178 offset:4128
    ds_read_b64_tr_b16 v[118:119], v178 offset:4640
    ds_read_b64_tr_b16 v[120:121], v178 offset:4160
    ds_read_b64_tr_b16 v[122:123], v178 offset:4672
    ds_read_b64_tr_b16 v[124:125], v178 offset:4192
    ds_read_b64_tr_b16 v[126:127], v178 offset:4704
    v_mfma_f32_16x16x32_bf16 v[208:211], v[96:99], v[64:67], 0
    v_mfma_f32_16x16x32_bf16 v[212:215], v[100:103], v[64:67], 0
    v_mfma_f32_16x16x32_bf16 v[216:219], v[104:107], v[64:67], 0
    v_mfma_f32_16x16x32_bf16 v[220:223], v[108:111], v[64:67], 0
    s_waitcnt vmcnt(20)
    s_waitcnt lgkmcnt(0)
    ds_read_b64_tr_b16 v[128:129], v178 offset:8192
    ds_read_b64_tr_b16 v[130:131], v178 offset:8704
    ds_read_b64_tr_b16 v[132:133], v178 offset:8224
    ds_read_b64_tr_b16 v[134:135], v178 offset:8736
    ds_read_b64_tr_b16 v[136:137], v178 offset:8256
    ds_read_b64_tr_b16 v[138:139], v178 offset:8768
    ds_read_b64_tr_b16 v[140:141], v178 offset:8288
    ds_read_b64_tr_b16 v[142:143], v178 offset:8800
    v_mfma_f32_16x16x32_bf16 v[208:211], v[112:115], v[68:71], v[208:211]
    v_mfma_f32_16x16x32_bf16 v[212:215], v[116:119], v[68:71], v[212:215]
    v_mfma_f32_16x16x32_bf16 v[216:219], v[120:123], v[68:71], v[216:219]
    v_mfma_f32_16x16x32_bf16 v[220:223], v[124:127], v[68:71], v[220:223]
    s_waitcnt vmcnt(15)
    s_waitcnt lgkmcnt(0)
    ds_read_b64_tr_b16 v[96:97], v178 offset:12288
    ds_read_b64_tr_b16 v[98:99], v178 offset:12800
    ds_read_b64_tr_b16 v[100:101], v178 offset:12320
    ds_read_b64_tr_b16 v[102:103], v178 offset:12832
    ds_read_b64_tr_b16 v[104:105], v178 offset:12352
    ds_read_b64_tr_b16 v[106:107], v178 offset:12864
    ds_read_b64_tr_b16 v[108:109], v178 offset:12384
    ds_read_b64_tr_b16 v[110:111], v178 offset:12896
    v_mfma_f32_16x16x32_bf16 v[208:211], v[128:131], v[72:75], v[208:211]
    v_mfma_f32_16x16x32_bf16 v[212:215], v[132:135], v[72:75], v[212:215]
    v_mfma_f32_16x16x32_bf16 v[216:219], v[136:139], v[72:75], v[216:219]
    v_mfma_f32_16x16x32_bf16 v[220:223], v[140:143], v[72:75], v[220:223]
    s_waitcnt vmcnt(10)
    s_waitcnt lgkmcnt(0)
    ds_read_b64_tr_b16 v[112:113], v178 offset:16384
    ds_read_b64_tr_b16 v[114:115], v178 offset:16896
    ds_read_b64_tr_b16 v[116:117], v178 offset:16416
    ds_read_b64_tr_b16 v[118:119], v178 offset:16928
    ds_read_b64_tr_b16 v[120:121], v178 offset:16448
    ds_read_b64_tr_b16 v[122:123], v178 offset:16960
    ds_read_b64_tr_b16 v[124:125], v178 offset:16480
    ds_read_b64_tr_b16 v[126:127], v178 offset:16992
    v_mfma_f32_16x16x32_bf16 v[208:211], v[96:99], v[76:79], v[208:211]
    v_mfma_f32_16x16x32_bf16 v[212:215], v[100:103], v[76:79], v[212:215]
    v_mfma_f32_16x16x32_bf16 v[216:219], v[104:107], v[76:79], v[216:219]
    v_mfma_f32_16x16x32_bf16 v[220:223], v[108:111], v[76:79], v[220:223]
    s_waitcnt vmcnt(5)
    s_waitcnt lgkmcnt(0)
    ds_read_b64_tr_b16 v[128:129], v178 offset:20480
    ds_read_b64_tr_b16 v[130:131], v178 offset:20992
    ds_read_b64_tr_b16 v[132:133], v178 offset:20512
    ds_read_b64_tr_b16 v[134:135], v178 offset:21024
    ds_read_b64_tr_b16 v[136:137], v178 offset:20544
    ds_read_b64_tr_b16 v[138:139], v178 offset:21056
    ds_read_b64_tr_b16 v[140:141], v178 offset:20576
    ds_read_b64_tr_b16 v[142:143], v178 offset:21088
    v_mfma_f32_16x16x32_bf16 v[208:211], v[112:115], v[80:83], v[208:211]
    v_mfma_f32_16x16x32_bf16 v[212:215], v[116:119], v[80:83], v[212:215]
    v_mfma_f32_16x16x32_bf16 v[216:219], v[120:123], v[80:83], v[216:219]
    v_mfma_f32_16x16x32_bf16 v[220:223], v[124:127], v[80:83], v[220:223]
    s_waitcnt vmcnt(0)
    s_mov_b32 exec_hi, 0
    buffer_load_dwordx2 v[12:13], v57, s[60:63], s70 offen sc1
    s_mov_b32 exec_hi, -1
    s_waitcnt lgkmcnt(0)
    ds_read_b64_tr_b16 v[96:97], v178 offset:24576
    ds_read_b64_tr_b16 v[98:99], v178 offset:25088
    ds_read_b64_tr_b16 v[100:101], v178 offset:24608
    ds_read_b64_tr_b16 v[102:103], v178 offset:25120
    ds_read_b64_tr_b16 v[104:105], v178 offset:24640
    ds_read_b64_tr_b16 v[106:107], v178 offset:25152
    ds_read_b64_tr_b16 v[108:109], v178 offset:24672
    ds_read_b64_tr_b16 v[110:111], v178 offset:25184
    v_mfma_f32_16x16x32_bf16 v[208:211], v[128:131], v[84:87], v[208:211]
    v_mfma_f32_16x16x32_bf16 v[212:215], v[132:135], v[84:87], v[212:215]
    v_mfma_f32_16x16x32_bf16 v[216:219], v[136:139], v[84:87], v[216:219]
    v_mfma_f32_16x16x32_bf16 v[220:223], v[140:143], v[84:87], v[220:223]
    s_waitcnt lgkmcnt(0)
    v_mfma_f32_16x16x32_bf16 v[208:211], v[96:99], v[88:91], v[208:211]
    v_mfma_f32_16x16x32_bf16 v[212:215], v[100:103], v[88:91], v[212:215]
    v_mfma_f32_16x16x32_bf16 v[216:219], v[104:107], v[88:91], v[216:219]
    v_mfma_f32_16x16x32_bf16 v[220:223], v[108:111], v[88:91], v[220:223]
    s_add_u32 s56, s56, 2654435769
    s_addc_u32 s57, s57, 2135587861
    s_lshr_b32 s58, s57, 4
    s_getreg_b32 s78, hwreg(HW_REG_XCC_ID, 0, 4)
    s_lshl_b32 s59, s58, 4
    s_or_b32 s59, s59, s78
    v_mov_b32_dpp v208, v212 quad_perm:[0,1,2,3] row_mask:0xf bank_mask:2
    v_mov_b32_dpp v209, v213 quad_perm:[0,1,2,3] row_mask:0xf bank_mask:2
    v_mov_b32_dpp v210, v214 quad_perm:[0,1,2,3] row_mask:0xf bank_mask:2
    v_mov_b32_dpp v211, v215 quad_perm:[0,1,2,3] row_mask:0xf bank_mask:2
    v_mov_b32_dpp v208, v216 quad_perm:[0,1,2,3] row_mask:0xf bank_mask:4
    v_mov_b32_dpp v209, v217 quad_perm:[0,1,2,3] row_mask:0xf bank_mask:4
    v_mov_b32_dpp v210, v218 quad_perm:[0,1,2,3] row_mask:0xf bank_mask:4
    v_mov_b32_dpp v211, v219 quad_perm:[0,1,2,3] row_mask:0xf bank_mask:4
    v_mov_b32_dpp v208, v220 quad_perm:[0,1,2,3] row_mask:0xf bank_mask:8
    v_mov_b32_dpp v209, v221 quad_perm:[0,1,2,3] row_mask:0xf bank_mask:8
    v_mov_b32_dpp v210, v222 quad_perm:[0,1,2,3] row_mask:0xf bank_mask:8
    v_mov_b32_dpp v211, v223 quad_perm:[0,1,2,3] row_mask:0xf bank_mask:8
    ds_write_b128 v17, v[208:211] offset:32768
    ds_read_b128 v[208:211], v16 offset:32768
    s_waitcnt vmcnt(0) lgkmcnt(0)
    s_mov_b32 exec_hi, 0
    s_mov_b32 s88, 524288
    s_branch L_fl_chk
L_fl:
    s_sleep 16
    buffer_load_dwordx2 v[12:13], v57, s[60:63], s70 offen sc1
    s_sub_u32 s88, s88, 1
    s_cmp_eq_u32 s88, 0
    s_waitcnt vmcnt(0) lgkmcnt(0)
    s_cbranch_scc1 L_fl_go
L_fl_chk:
    v_lshrrev_b32 v55, 4, v13
    v_xor_b32 v55, s58, v55
    v_xor_b32 v56, s56, v12
    v_or_b32 v54, v55, v56
    v_cmp_ne_u32 vcc, 0, v54
    s_nop 0
    s_and_b64 exec, exec, vcc
    s_cbranch_scc1 L_fl
L_fl_go:
    s_mov_b64 exec, -1
    v_cmp_ne_u32 vcc, s59, v13
    s_nop 0
    s_cmp_eq_u32 vcc_lo, 0
    s_cselect_b32 s89, 1, 2
    v_mov_b32 v8, s56
    v_mov_b32 v9, s59
    s_lshl3_add_u32 s79, s73, s69
    s_cmp_eq_u32 s89, 1
    s_cbranch_scc1 L_first_l
    buffer_store_dwordx4 v[208:211], v16, s[60:63], s64 offen sc1
    buffer_store_dwordx4 v[34:37], v18, s[60:63], s50 offen sc1
    s_mov_b32 exec_hi, 0
    buffer_store_dwordx4 v[34:37], v18, s[60:63], s49 offen sc1
    s_mov_b32 exec_lo, 0xffff
    buffer_store_dwordx4 v[38:41], v16, s[60:63], s51 offen sc1
    s_mov_b32 exec_lo, 0xff
    buffer_store_dwordx4 v[34:37], v16, s[60:63], s48 offen sc1
    s_mov_b32 exec_lo, 1
    s_waitcnt vmcnt(0)
    buffer_store_dwordx2 v[8:9], off, s[60:63], s79 offset:256 sc1
    s_branch L_first_d
L_first_l:
    buffer_store_dwordx4 v[208:211], v16, s[60:63], s64 offen
    buffer_store_dwordx4 v[34:37], v18, s[60:63], s50 offen
    s_mov_b32 exec_hi, 0
    buffer_store_dwordx4 v[34:37], v18, s[60:63], s49 offen
    s_mov_b32 exec_lo, 0xffff
    buffer_store_dwordx4 v[38:41], v16, s[60:63], s51 offen
    s_mov_b32 exec_lo, 0xff
    buffer_store_dwordx4 v[34:37], v16, s[60:63], s48 offen
    s_mov_b32 exec_lo, 1
    s_waitcnt vmcnt(0)
    buffer_store_dwordx2 v[8:9], off, s[60:63], s79 offset:256
L_first_d:
    s_mov_b32 exec_lo, -1
    s_mov_b32 s88, 524288
L_rd:
    s_sleep 2
    buffer_load_dwordx2 v[12:13], v7, s[60:63], s69 offen offset:256 sc1
    s_sub_u32 s88, s88, 1
    s_cmp_eq_u32 s88, 0
    s_waitcnt vmcnt(0) lgkmcnt(0)
    s_cbranch_scc1 L_rd_go
    v_lshrrev_b32 v55, 4, v13
    v_xor_b32 v55, s58, v55
    v_xor_b32 v56, s56, v12
    v_or_b32 v54, v55, v56
    v_cmp_ne_u32 vcc, 0, v54
    s_nop 0
    s_and_b64 exec, exec, vcc
    s_cbranch_scc1 L_rd
L_rd_go:
    s_mov_b64 exec, -1
    v_lshlrev_b32 v54, 4, v61
    v_lshl_add_u32 v54, v60, 10, v54
    s_lshr_b32 s78, s73, 3
    s_lshl_b32 s78, s78, 8
    s_lshl_b32 s79, s72, 13
    s_add_u32 s78, s78, s79
    s_add_u32 s78, s78, 0x20000
    s_lshl4_add_u32 s80, s74, s75
    s_lshl_b32 s80, s80, 8
    s_add_u32 s79, s80, 0
    buffer_load_dwordx4 v[80:83], v54, s[60:63], s79 offen sc1 nt
    s_add_u32 s79, s80, 65536
    buffer_load_dwordx4 v[84:87], v54, s[60:63], s79 offen sc1 nt
    s_add_u32 s79, s78, 0
    buffer_load_dwordx4 v[64:67], v54, s[60:63], s79 offen sc1 nt
    s_add_u32 s79, s78, 65536
    buffer_load_dwordx4 v[68:71], v54, s[60:63], s79 offen sc1 nt
    s_add_u32 s79, s78, 4096
    buffer_load_dwordx4 v[72:75], v54, s[60:63], s79 offen sc1 nt
    s_add_u32 s79, s78, 69632
    buffer_load_dwordx4 v[76:79], v54, s[60:63], s79 offen sc1 nt
    s_mov_b32 s79, 937984
    s_mov_b64 exec, 0xff
    s_mov_b32 s88, 524288
L_ch:
    s_sleep 1
    buffer_load_dwordx2 v[12:13], v57, s[60:63], s79 offen sc1
    s_sub_u32 s88, s88, 1
    s_cmp_eq_u32 s88, 0
    s_waitcnt vmcnt(0) lgkmcnt(0)
    s_cbranch_scc1 L_ch_go
    v_lshrrev_b32 v55, 4, v13
    v_xor_b32 v55, s58, v55
    v_xor_b32 v56, s56, v12
    v_or_b32 v54, v55, v56
    v_cmp_ne_u32 vcc, 0, v54
    s_nop 0
    s_and_b64 exec, exec, vcc
    s_cbranch_scc1 L_ch
L_ch_go:
    s_mov_b64 exec, -1
    v_and_b32 v12, 1, v13
    v_cmp_ne_u32 vcc, 0, v12
    s_nop 0
    s_and_b32 s78, vcc_lo, 0xff
    v_and_b32 v12, 2, v13
    v_cmp_ne_u32 vcc, 0, v12
    s_nop 0
    s_and_b32 s79, vcc_lo, 0xff
    v_and_b32 v12, 4, v13
    v_cmp_ne_u32 vcc, 0, v12
    s_nop 0
    s_and_b32 s71, vcc_lo, 0xff
    s_bcnt1_i32_b32 s78, s78
    s_bcnt1_i32_b32 s79, s79
    s_cmp_gt_u32 s79, s78
    s_cselect_b32 s78, 0xff, 0
    s_xor_b32 s71, s71, s78
    v_mov_b32 v54, 46596
    v_mov_b32 v55, s89
    v_mov_b32 v56, s71
    ds_write2_b32 v54, v55, v56 offset0:0 offset1:1
    v_add_f32 v64, v64, v68
    v_add_f32 v65, v65, v69
    v_add_f32 v66, v66, v70
    v_add_f32 v67, v67, v71
    v_cvt_pk_bf16_f32 v64, v64, v65
    v_cvt_pk_bf16_f32 v65, v66, v67
    ds_write_b64 v7, v[64:65] offset:45056
    v_add_f32 v72, v72, v76
    v_add_f32 v73, v73, v77
    v_add_f32 v74, v74, v78
    v_add_f32 v75, v75, v79
    v_cvt_pk_bf16_f32 v72, v72, v73
    v_cvt_pk_bf16_f32 v73, v74, v75
    ds_write_b64 v7, v[72:73] offset:45568
    v_add_f32 v80, v80, v84
    v_add_f32 v81, v81, v85
    v_add_f32 v82, v82, v86
    v_add_f32 v83, v83, v87
    v_cvt_pk_bf16_f32 v80, v80, v81
    v_cvt_pk_bf16_f32 v81, v82, v83
    ds_write_b64 v7, v[80:81] offset:46080
    s_waitcnt lgkmcnt(0)
    s_barrier
    v_mov_b32 v57, 0
    s_lshl2_add_u32 s78, s74, s75
    s_and_b32 s79, s73, 3
    s_lshl3_add_u32 s78, s78, s79
    s_lshl_b32 s79, s72, 6
    s_add_u32 s79, s79, s73
    s_add_u32 s79, s79, 512
    v_lshrrev_b32 v54, 2, v0
    v_lshl_add_u32 v54, v54, 5, s79
    v_mov_b32 v55, s78
    v_cmp_lt_u32 vcc, 7, v0
    s_nop 1
    v_cndmask_b32 v54, v54, v55, vcc
    v_and_b32 v55, 3, v0
    v_lshl_add_u32 v54, v54, 2, v55
    v_lshlrev_b32 v52, 3, v54
    s_mov_b32 s80, 262144
    s_and_b32 s77, s73, 0
    s_add_u32 s77, s77, 45
    s_mov_b32 s88, 524288
L_w0:
    s_sleep 8
    ds_read_b128 v[8:11], v57 offset:46608
    s_sub_u32 s88, s88, 1
    s_cmp_eq_u32 s88, 0
    s_waitcnt vmcnt(0) lgkmcnt(0)
    s_cbranch_scc1 L_w0_go
    v_min3_u32 v8, v8, v9, v10
    v_min_u32 v8, v8, v11
    v_cmp_gt_u32 vcc, s77, v8
    s_nop 0
    s_cbranch_vccnz L_w0
L_w0_go:
    ds_read_b64 v[12:13], v7 offset:46656
    s_waitcnt lgkmcnt(0)
    v_min_u32 v12, -2, v12
    v_min_u32 v13, -2, v13
    s_mov_b64 exec, 0xfff
    s_cmp_eq_u32 s89, 1
    s_cbranch_scc1 L_ml_l
    buffer_store_dwordx2 v[12:13], v52, s[60:63], s80 offen sc1
    s_branch L_ml_d
L_ml_l:
    buffer_store_dwordx2 v[12:13], v52, s[60:63], s80 offen
L_ml_d:
    s_mov_b64 exec, -1
    s_lshl2_add_u32 s78, s74, s75
    s_lshl_b32 s78, s78, 8
    s_add_u32 s78, s78, 262144
    s_lshr_b32 s79, s73, 3
    s_lshl3_add_u32 s79, s72, s79
    s_lshl_b32 s79, s79, 8
    s_add_u32 s79, s79, 278528
    v_lshlrev_b32 v48, 3, v61
    v_and_b32 v54, 31, v0
    v_lshlrev_b32 v54, 3, v54
    v_lshrrev_b32 v55, 5, v0
    v_lshl_add_u32 v49, v55, 10, v54
    s_and_b32 s77, s73, 0
    s_add_u32 s77, s77, 54
    s_mov_b32 s88, 524288
L_w1:
    s_sleep 8
    ds_read_b128 v[8:11], v57 offset:46608
    s_sub_u32 s88, s88, 1
    s_cmp_eq_u32 s88, 0
    s_waitcnt vmcnt(0) lgkmcnt(0)
    s_cbranch_scc1 L_w1_go
    v_min3_u32 v8, v8, v9, v10
    v_min_u32 v8, v8, v11
    v_cmp_gt_u32 vcc, s77, v8
    s_nop 0
    s_cbranch_vccnz L_w1
L_w1_go:
    s_mov_b32 s88, 524288
L_ml:
    s_sleep 4
    buffer_load_dwordx2 v[138:139], v48, s[60:63], s78 offen sc1 nt
    buffer_load_dwordx2 v[140:141], v49, s[60:63], s79 offen sc1 nt
    s_sub_u32 s88, s88, 1
    s_cmp_eq_u32 s88, 0
    s_waitcnt vmcnt(0) lgkmcnt(0)
    s_cbranch_scc1 L_ml_go
    v_max_u32 v54, v138, v139
    v_max_u32 v56, v140, v141
    v_max_u32 v54, v54, v56
    v_cmp_eq_u32 vcc, -1, v54
    s_nop 0
    s_cbranch_vccnz L_ml
L_ml_go:
    v_max_f32_dpp v50, v138, v138 row_ror:8 row_mask:0xf bank_mask:0xf
    v_max_f32_dpp v51, v140, v140 row_ror:8 row_mask:0xf bank_mask:0xf
    s_nop 0
    v_max_f32_dpp v50, v50, v50 row_ror:4 row_mask:0xf bank_mask:0xf
    v_max_f32_dpp v51, v51, v51 row_ror:4 row_mask:0xf bank_mask:0xf
    s_nop 0
    v_max_f32_dpp v50, v50, v50 row_ror:2 row_mask:0xf bank_mask:0xf
    v_max_f32_dpp v51, v51, v51 row_ror:2 row_mask:0xf bank_mask:0xf
    s_nop 0
    v_max_f32_dpp v50, v50, v50 row_ror:1 row_mask:0xf bank_mask:0xf
    v_max_f32_dpp v51, v51, v51 row_ror:1 row_mask:0xf bank_mask:0xf
    v_mov_b32 v55, v51
    s_nop 1
    v_permlane16_swap_b32 v51, v55
    v_max_f32 v51, v51, v55
    v_sub_f32 v138, v138, v50
    v_sub_f32 v140, v140, v51
    v_exp_f32 v138, v138
    v_exp_f32 v140, v140
    v_mul_f32 v50, v138, v139
    v_mul_f32 v51, v140, v141
    s_nop 0
    v_add_f32_dpp v50, v50, v50 row_ror:8 row_mask:0xf bank_mask:0xf
    v_add_f32_dpp v51, v51, v51 row_ror:8 row_mask:0xf bank_mask:0xf
    s_nop 0
    v_add_f32_dpp v50, v50, v50 row_ror:4 row_mask:0xf bank_mask:0xf
    v_add_f32_dpp v51, v51, v51 row_ror:4 row_mask:0xf bank_mask:0xf
    s_nop 0
    v_add_f32_dpp v50, v50, v50 row_ror:2 row_mask:0xf bank_mask:0xf
    v_add_f32_dpp v51, v51, v51 row_ror:2 row_mask:0xf bank_mask:0xf
    s_nop 0
    v_add_f32_dpp v50, v50, v50 row_ror:1 row_mask:0xf bank_mask:0xf
    v_add_f32_dpp v51, v51, v51 row_ror:1 row_mask:0xf bank_mask:0xf
    v_mov_b32 v55, v51
    s_nop 1
    v_permlane16_swap_b32 v51, v55
    v_add_f32 v51, v51, v55
    v_rcp_f32 v50, v50
    v_rcp_f32 v51, v51
    v_mul_f32 v50, v138, v50
    v_mul_f32 v51, v140, v51
    s_and_b32 s78, s73, 7
    s_lshl_b32 s78, s78, 2
    s_and_b32 s79, s78, 15
    s_add_u32 s80, s78, 0
    v_readlane_b32 s4, v51, s80
    s_add_u32 s80, s78, 1
    v_readlane_b32 s5, v51, s80
    s_add_u32 s80, s78, 2
    v_readlane_b32 s6, v51, s80
    s_add_u32 s80, s78, 3
    v_readlane_b32 s7, v51, s80
    s_add_u32 s80, s78, 32
    v_readlane_b32 s8, v51, s80
    s_add_u32 s80, s78, 33
    v_readlane_b32 s9, v51, s80
    s_add_u32 s80, s78, 34
    v_readlane_b32 s10, v51, s80
    s_add_u32 s80, s78, 35
    v_readlane_b32 s11, v51, s80
    s_add_u32 s80, s79, 0
    v_readlane_b32 s12, v50, s80
    s_add_u32 s80, s79, 1
    v_readlane_b32 s13, v50, s80
    s_add_u32 s80, s79, 2
    v_readlane_b32 s14, v50, s80
    s_add_u32 s80, s79, 3
    v_readlane_b32 s15, v50, s80
    s_add_u32 s78, s83, 16384
    s_cmp_eq_u32 s89, 1
    ds_read_b128 v[184:187], v16 offset:32768
    ds_read_b128 v[188:191], v16 offset:33792
    ds_read_b128 v[192:195], v16 offset:34816
    ds_read_b128 v[196:199], v16 offset:35840
    s_waitcnt lgkmcnt(3)
    v_mul_f32 v184, s4, v184
    v_mul_f32 v185, s4, v185
    v_mul_f32 v186, s4, v186
    v_mul_f32 v187, s4, v187
    s_waitcnt lgkmcnt(2)
    v_fmac_f32 v184, s5, v188
    v_fmac_f32 v185, s5, v189
    v_fmac_f32 v186, s5, v190
    v_fmac_f32 v187, s5, v191
    s_waitcnt lgkmcnt(1)
    v_fmac_f32 v184, s6, v192
    v_fmac_f32 v185, s6, v193
    v_fmac_f32 v186, s6, v194
    v_fmac_f32 v187, s6, v195
    s_waitcnt lgkmcnt(0)
    v_fmac_f32 v184, s7, v196
    v_fmac_f32 v185, s7, v197
    v_fmac_f32 v186, s7, v198
    v_fmac_f32 v187, s7, v199
    v_cvt_pk_bf16_f32 v184, v184, v185
    v_cvt_pk_bf16_f32 v185, v186, v187
    v_min_u32 v200, -2, v184
    v_min_u32 v201, -2, v185
    s_cbranch_scc1 L_pub0_l
    buffer_store_dwordx2 v[200:201], v179, s[60:63], s83 offen sc1
    s_branch L_pub0_d
L_pub0_l:
    buffer_store_dwordx2 v[200:201], v179, s[60:63], s83 offen
L_pub0_d:
    ds_read_b128 v[184:187], v16 offset:36864
    ds_read_b128 v[188:191], v16 offset:37888
    ds_read_b128 v[192:195], v16 offset:38912
    ds_read_b128 v[196:199], v16 offset:39936
    s_waitcnt lgkmcnt(3)
    v_mul_f32 v184, s8, v184
    v_mul_f32 v185, s8, v185
    v_mul_f32 v186, s8, v186
    v_mul_f32 v187, s8, v187
    s_waitcnt lgkmcnt(2)
    v_fmac_f32 v184, s9, v188
    v_fmac_f32 v185, s9, v189
    v_fmac_f32 v186, s9, v190
    v_fmac_f32 v187, s9, v191
    s_waitcnt lgkmcnt(1)
    v_fmac_f32 v184, s10, v192
    v_fmac_f32 v185, s10, v193
    v_fmac_f32 v186, s10, v194
    v_fmac_f32 v187, s10, v195
    s_waitcnt lgkmcnt(0)
    v_fmac_f32 v184, s11, v196
    v_fmac_f32 v185, s11, v197
    v_fmac_f32 v186, s11, v198
    v_fmac_f32 v187, s11, v199
    v_cvt_pk_bf16_f32 v184, v184, v185
    v_cvt_pk_bf16_f32 v185, v186, v187
    v_min_u32 v202, -2, v184
    v_min_u32 v203, -2, v185
    s_cbranch_scc1 L_pub1_l
    buffer_store_dwordx2 v[202:203], v179, s[60:63], s78 offen sc1
    s_branch L_pub1_d
L_pub1_l:
    buffer_store_dwordx2 v[202:203], v179, s[60:63], s78 offen
L_pub1_d:
    s_cmp_ge_u32 s73, 28
    s_cbranch_scc1 L_h_nos2
    s_add_u32 s78, s84, 8192
    s_and_b32 s77, s73, 0
    s_add_u32 s77, s77, 62
    s_mov_b32 s88, 524288
L_w2:
    s_sleep 8
    ds_read_b128 v[8:11], v57 offset:46608
    s_sub_u32 s88, s88, 1
    s_cmp_eq_u32 s88, 0
    s_waitcnt vmcnt(0) lgkmcnt(0)
    s_cbranch_scc1 L_w2_go
    v_min3_u32 v8, v8, v9, v10
    v_min_u32 v8, v8, v11
    v_cmp_gt_u32 vcc, s77, v8
    s_nop 0
    s_cbranch_vccnz L_w2
L_w2_go:
    s_mov_b32 s88, 524288
L_s2b:
    s_sleep 16
    buffer_load_dwordx4 v[128:131], v176, s[60:63], s84 offen offset:0 sc1 nt
    buffer_load_dwordx4 v[132:135], v176, s[60:63], s84 offen offset:1024 sc1 nt
    buffer_load_dwordx4 v[136:139], v176, s[60:63], s84 offen offset:2048 sc1 nt
    buffer_load_dwordx4 v[140:143], v176, s[60:63], s84 offen offset:3072 sc1 nt
    buffer_load_dwordx4 v[144:147], v176, s[60:63], s78 offen offset:0 sc1 nt
    buffer_load_dwordx4 v[148:151], v176, s[60:63], s78 offen offset:1024 sc1 nt
    buffer_load_dwordx4 v[152:155], v176, s[60:63], s78 offen offset:2048 sc1 nt
    buffer_load_dwordx4 v[156:159], v176, s[60:63], s78 offen offset:3072 sc1 nt
    s_sub_u32 s88, s88, 1
    s_cmp_eq_u32 s88, 0
    s_waitcnt vmcnt(0) lgkmcnt(0)
    s_cbranch_scc1 L_s2b_go
    v_max_u32 v54, v128, v129
    v_max_u32 v56, v130, v131
    v_max3_u32 v54, v54, v132, v133
    v_max3_u32 v56, v56, v134, v135
    v_max3_u32 v54, v54, v136, v137
    v_max3_u32 v56, v56, v138, v139
    v_max3_u32 v54, v54, v140, v141
    v_max3_u32 v56, v56, v142, v143
    v_max3_u32 v54, v54, v144, v145
    v_max3_u32 v56, v56, v146, v147
    v_max3_u32 v54, v54, v148, v149
    v_max3_u32 v56, v56, v150, v151
    v_max3_u32 v54, v54, v152, v153
    v_max3_u32 v56, v56, v154, v155
    v_max3_u32 v54, v54, v156, v157
    v_max3_u32 v56, v56, v158, v159
    v_max_u32 v54, v54, v56
    v_cmp_eq_u32 vcc, -1, v54
    s_nop 0
    s_and_b64 exec, exec, vcc
    s_cbranch_scc1 L_s2b
L_s2b_go:
    s_mov_b64 exec, -1
    v_lshlrev_b32 v160, 16, v128
    v_lshlrev_b32 v54, 16, v144
    v_and_b32 v128, 0xffff0000, v128
    v_and_b32 v144, 0xffff0000, v144
    v_add_f32 v160, v160, v54
    v_add_f32 v128, v128, v144
    v_lshlrev_b32 v161, 16, v129
    v_lshlrev_b32 v54, 16, v145
    v_and_b32 v129, 0xffff0000, v129
    v_and_b32 v145, 0xffff0000, v145
    v_add_f32 v161, v161, v54
    v_add_f32 v129, v129, v145
    v_lshlrev_b32 v162, 16, v130
    v_lshlrev_b32 v54, 16, v146
    v_and_b32 v130, 0xffff0000, v130
    v_and_b32 v146, 0xffff0000, v146
    v_add_f32 v162, v162, v54
    v_add_f32 v130, v130, v146
    v_lshlrev_b32 v163, 16, v131
    v_lshlrev_b32 v54, 16, v147
    v_and_b32 v131, 0xffff0000, v131
    v_and_b32 v147, 0xffff0000, v147
    v_add_f32 v163, v163, v54
    v_add_f32 v131, v131, v147
    v_lshlrev_b32 v164, 16, v132
    v_lshlrev_b32 v54, 16, v148
    v_and_b32 v132, 0xffff0000, v132
    v_and_b32 v148, 0xffff0000, v148
    v_add_f32 v164, v164, v54
    v_add_f32 v132, v132, v148
    v_lshlrev_b32 v165, 16, v133
    v_lshlrev_b32 v54, 16, v149
    v_and_b32 v133, 0xffff0000, v133
    v_and_b32 v149, 0xffff0000, v149
    v_add_f32 v165, v165, v54
    v_add_f32 v133, v133, v149
    v_lshlrev_b32 v166, 16, v134
    v_lshlrev_b32 v54, 16, v150
    v_and_b32 v134, 0xffff0000, v134
    v_and_b32 v150, 0xffff0000, v150
    v_add_f32 v166, v166, v54
    v_add_f32 v134, v134, v150
    v_lshlrev_b32 v167, 16, v135
    v_lshlrev_b32 v54, 16, v151
    v_and_b32 v135, 0xffff0000, v135
    v_and_b32 v151, 0xffff0000, v151
    v_add_f32 v167, v167, v54
    v_add_f32 v135, v135, v151
    v_lshlrev_b32 v168, 16, v136
    v_lshlrev_b32 v54, 16, v152
    v_and_b32 v136, 0xffff0000, v136
    v_and_b32 v152, 0xffff0000, v152
    v_add_f32 v168, v168, v54
    v_add_f32 v136, v136, v152
    v_lshlrev_b32 v169, 16, v137
    v_lshlrev_b32 v54, 16, v153
    v_and_b32 v137, 0xffff0000, v137
    v_and_b32 v153, 0xffff0000, v153
    v_add_f32 v169, v169, v54
    v_add_f32 v137, v137, v153
    v_lshlrev_b32 v170, 16, v138
    v_lshlrev_b32 v54, 16, v154
    v_and_b32 v138, 0xffff0000, v138
    v_and_b32 v154, 0xffff0000, v154
    v_add_f32 v170, v170, v54
    v_add_f32 v138, v138, v154
    v_lshlrev_b32 v171, 16, v139
    v_lshlrev_b32 v54, 16, v155
    v_and_b32 v139, 0xffff0000, v139
    v_and_b32 v155, 0xffff0000, v155
    v_add_f32 v171, v171, v54
    v_add_f32 v139, v139, v155
    v_lshlrev_b32 v172, 16, v140
    v_lshlrev_b32 v54, 16, v156
    v_and_b32 v140, 0xffff0000, v140
    v_and_b32 v156, 0xffff0000, v156
    v_add_f32 v172, v172, v54
    v_add_f32 v140, v140, v156
    v_lshlrev_b32 v173, 16, v141
    v_lshlrev_b32 v54, 16, v157
    v_and_b32 v141, 0xffff0000, v141
    v_and_b32 v157, 0xffff0000, v157
    v_add_f32 v173, v173, v54
    v_add_f32 v141, v141, v157
    v_lshlrev_b32 v174, 16, v142
    v_lshlrev_b32 v54, 16, v158
    v_and_b32 v142, 0xffff0000, v142
    v_and_b32 v158, 0xffff0000, v158
    v_add_f32 v174, v174, v54
    v_add_f32 v142, v142, v158
    v_lshlrev_b32 v175, 16, v143
    v_lshlrev_b32 v54, 16, v159
    v_and_b32 v143, 0xffff0000, v143
    v_and_b32 v159, 0xffff0000, v159
    v_add_f32 v175, v175, v54
    v_add_f32 v143, v143, v159
    v_add_f32_dpp v160, v160, v160 quad_perm:[1,0,3,2] row_mask:0xf bank_mask:0xf
    v_add_f32_dpp v128, v128, v128 quad_perm:[1,0,3,2] row_mask:0xf bank_mask:0xf
    v_add_f32_dpp v161, v161, v161 quad_perm:[1,0,3,2] row_mask:0xf bank_mask:0xf
    v_add_f32_dpp v129, v129, v129 quad_perm:[1,0,3,2] row_mask:0xf bank_mask:0xf
    v_add_f32_dpp v162, v162, v162 quad_perm:[1,0,3,2] row_mask:0xf bank_mask:0xf
    v_add_f32_dpp v130, v130, v130 quad_perm:[1,0,3,2] row_mask:0xf bank_mask:0xf
    v_add_f32_dpp v163, v163, v163 quad_perm:[1,0,3,2] row_mask:0xf bank_mask:0xf
    v_add_f32_dpp v131, v131, v131 quad_perm:[1,0,3,2] row_mask:0xf bank_mask:0xf
    v_add_f32_dpp v164, v164, v164 quad_perm:[1,0,3,2] row_mask:0xf bank_mask:0xf
    v_add_f32_dpp v132, v132, v132 quad_perm:[1,0,3,2] row_mask:0xf bank_mask:0xf
    v_add_f32_dpp v165, v165, v165 quad_perm:[1,0,3,2] row_mask:0xf bank_mask:0xf
    v_add_f32_dpp v133, v133, v133 quad_perm:[1,0,3,2] row_mask:0xf bank_mask:0xf
    v_add_f32_dpp v166, v166, v166 quad_perm:[1,0,3,2] row_mask:0xf bank_mask:0xf
    v_add_f32_dpp v134, v134, v134 quad_perm:[1,0,3,2] row_mask:0xf bank_mask:0xf
    v_add_f32_dpp v167, v167, v167 quad_perm:[1,0,3,2] row_mask:0xf bank_mask:0xf
    v_add_f32_dpp v135, v135, v135 quad_perm:[1,0,3,2] row_mask:0xf bank_mask:0xf
    v_add_f32_dpp v168, v168, v168 quad_perm:[1,0,3,2] row_mask:0xf bank_mask:0xf
    v_add_f32_dpp v136, v136, v136 quad_perm:[1,0,3,2] row_mask:0xf bank_mask:0xf
    v_add_f32_dpp v169, v169, v169 quad_perm:[1,0,3,2] row_mask:0xf bank_mask:0xf
    v_add_f32_dpp v137, v137, v137 quad_perm:[1,0,3,2] row_mask:0xf bank_mask:0xf
    v_add_f32_dpp v170, v170, v170 quad_perm:[1,0,3,2] row_mask:0xf bank_mask:0xf
    v_add_f32_dpp v138, v138, v138 quad_perm:[1,0,3,2] row_mask:0xf bank_mask:0xf
    v_add_f32_dpp v171, v171, v171 quad_perm:[1,0,3,2] row_mask:0xf bank_mask:0xf
    v_add_f32_dpp v139, v139, v139 quad_perm:[1,0,3,2] row_mask:0xf bank_mask:0xf
    v_add_f32_dpp v172, v172, v172 quad_perm:[1,0,3,2] row_mask:0xf bank_mask:0xf
    v_add_f32_dpp v140, v140, v140 quad_perm:[1,0,3,2] row_mask:0xf bank_mask:0xf
    v_add_f32_dpp v173, v173, v173 quad_perm:[1,0,3,2] row_mask:0xf bank_mask:0xf
    v_add_f32_dpp v141, v141, v141 quad_perm:[1,0,3,2] row_mask:0xf bank_mask:0xf
    v_add_f32_dpp v174, v174, v174 quad_perm:[1,0,3,2] row_mask:0xf bank_mask:0xf
    v_add_f32_dpp v142, v142, v142 quad_perm:[1,0,3,2] row_mask:0xf bank_mask:0xf
    v_add_f32_dpp v175, v175, v175 quad_perm:[1,0,3,2] row_mask:0xf bank_mask:0xf
    v_add_f32_dpp v143, v143, v143 quad_perm:[1,0,3,2] row_mask:0xf bank_mask:0xf
    v_add_f32_dpp v160, v160, v160 quad_perm:[2,3,0,1] row_mask:0xf bank_mask:0xf
    v_add_f32_dpp v128, v128, v128 quad_perm:[2,3,0,1] row_mask:0xf bank_mask:0xf
    v_add_f32_dpp v161, v161, v161 quad_perm:[2,3,0,1] row_mask:0xf bank_mask:0xf
    v_add_f32_dpp v129, v129, v129 quad_perm:[2,3,0,1] row_mask:0xf bank_mask:0xf
    v_add_f32_dpp v162, v162, v162 quad_perm:[2,3,0,1] row_mask:0xf bank_mask:0xf
    v_add_f32_dpp v130, v130, v130 quad_perm:[2,3,0,1] row_mask:0xf bank_mask:0xf
    v_add_f32_dpp v163, v163, v163 quad_perm:[2,3,0,1] row_mask:0xf bank_mask:0xf
    v_add_f32_dpp v131, v131, v131 quad_perm:[2,3,0,1] row_mask:0xf bank_mask:0xf
    v_add_f32_dpp v164, v164, v164 quad_perm:[2,3,0,1] row_mask:0xf bank_mask:0xf
    v_add_f32_dpp v132, v132, v132 quad_perm:[2,3,0,1] row_mask:0xf bank_mask:0xf
    v_add_f32_dpp v165, v165, v165 quad_perm:[2,3,0,1] row_mask:0xf bank_mask:0xf
    v_add_f32_dpp v133, v133, v133 quad_perm:[2,3,0,1] row_mask:0xf bank_mask:0xf
    v_add_f32_dpp v166, v166, v166 quad_perm:[2,3,0,1] row_mask:0xf bank_mask:0xf
    v_add_f32_dpp v134, v134, v134 quad_perm:[2,3,0,1] row_mask:0xf bank_mask:0xf
    v_add_f32_dpp v167, v167, v167 quad_perm:[2,3,0,1] row_mask:0xf bank_mask:0xf
    v_add_f32_dpp v135, v135, v135 quad_perm:[2,3,0,1] row_mask:0xf bank_mask:0xf
    v_add_f32_dpp v168, v168, v168 quad_perm:[2,3,0,1] row_mask:0xf bank_mask:0xf
    v_add_f32_dpp v136, v136, v136 quad_perm:[2,3,0,1] row_mask:0xf bank_mask:0xf
    v_add_f32_dpp v169, v169, v169 quad_perm:[2,3,0,1] row_mask:0xf bank_mask:0xf
    v_add_f32_dpp v137, v137, v137 quad_perm:[2,3,0,1] row_mask:0xf bank_mask:0xf
    v_add_f32_dpp v170, v170, v170 quad_perm:[2,3,0,1] row_mask:0xf bank_mask:0xf
    v_add_f32_dpp v138, v138, v138 quad_perm:[2,3,0,1] row_mask:0xf bank_mask:0xf
    v_add_f32_dpp v171, v171, v171 quad_perm:[2,3,0,1] row_mask:0xf bank_mask:0xf
    v_add_f32_dpp v139, v139, v139 quad_perm:[2,3,0,1] row_mask:0xf bank_mask:0xf
    v_add_f32_dpp v172, v172, v172 quad_perm:[2,3,0,1] row_mask:0xf bank_mask:0xf
    v_add_f32_dpp v140, v140, v140 quad_perm:[2,3,0,1] row_mask:0xf bank_mask:0xf
    v_add_f32_dpp v173, v173, v173 quad_perm:[2,3,0,1] row_mask:0xf bank_mask:0xf
    v_add_f32_dpp v141, v141, v141 quad_perm:[2,3,0,1] row_mask:0xf bank_mask:0xf
    v_add_f32_dpp v174, v174, v174 quad_perm:[2,3,0,1] row_mask:0xf bank_mask:0xf
    v_add_f32_dpp v142, v142, v142 quad_perm:[2,3,0,1] row_mask:0xf bank_mask:0xf
    v_add_f32_dpp v175, v175, v175 quad_perm:[2,3,0,1] row_mask:0xf bank_mask:0xf
    v_add_f32_dpp v143, v143, v143 quad_perm:[2,3,0,1] row_mask:0xf bank_mask:0xf
    v_cvt_pk_bf16_f32 v128, v160, v128
    v_cvt_pk_bf16_f32 v129, v161, v129
    v_cvt_pk_bf16_f32 v130, v162, v130
    v_cvt_pk_bf16_f32 v131, v163, v131
    v_cvt_pk_bf16_f32 v132, v164, v132
    v_cvt_pk_bf16_f32 v133, v165, v133
    v_cvt_pk_bf16_f32 v134, v166, v134
    v_cvt_pk_bf16_f32 v135, v167, v135
    v_cvt_pk_bf16_f32 v136, v168, v136
    v_cvt_pk_bf16_f32 v137, v169, v137
    v_cvt_pk_bf16_f32 v138, v170, v138
    v_cvt_pk_bf16_f32 v139, v171, v139
    v_cvt_pk_bf16_f32 v140, v172, v140
    v_cvt_pk_bf16_f32 v141, v173, v141
    v_cvt_pk_bf16_f32 v142, v174, v142
    v_cvt_pk_bf16_f32 v143, v175, v143
    ds_write_b128 v16, v[128:131] offset:32768
    ds_write_b128 v16, v[132:135] offset:33792
    ds_write_b128 v16, v[136:139] offset:34816
    ds_write_b128 v16, v[140:143] offset:35840
L_h_nos2:
    s_cmp_eq_u32 s89, 1
    s_waitcnt lgkmcnt(0)
    s_barrier
    ds_read_b128 v[184:187], v16 offset:40960
    ds_read_b128 v[188:191], v16 offset:41984
    ds_read_b128 v[192:195], v16 offset:43008
    ds_read_b128 v[196:199], v16 offset:44032
    s_waitcnt lgkmcnt(3)
    v_mul_f32 v184, s12, v184
    v_mul_f32 v185, s12, v185
    v_mul_f32 v186, s12, v186
    v_mul_f32 v187, s12, v187
    s_waitcnt lgkmcnt(2)
    v_fmac_f32 v184, s13, v188
    v_fmac_f32 v185, s13, v189
    v_fmac_f32 v186, s13, v190
    v_fmac_f32 v187, s13, v191
    s_waitcnt lgkmcnt(1)
    v_fmac_f32 v184, s14, v192
    v_fmac_f32 v185, s14, v193
    v_fmac_f32 v186, s14, v194
    v_fmac_f32 v187, s14, v195
    s_waitcnt lgkmcnt(0)
    v_fmac_f32 v184, s15, v196
    v_fmac_f32 v185, s15, v197
    v_fmac_f32 v186, s15, v198
    v_fmac_f32 v187, s15, v199
    v_cvt_pk_bf16_f32 v184, v184, v185
    v_cvt_pk_bf16_f32 v185, v186, v187
    v_min_u32 v204, -2, v184
    v_min_u32 v205, -2, v185
    s_cbranch_scc1 L_pub2_l
    buffer_store_dwordx2 v[204:205], v179, s[60:63], s82 offen sc1
    s_branch L_pub2_d
L_pub2_l:
    buffer_store_dwordx2 v[204:205], v179, s[60:63], s82 offen
L_pub2_d:
    s_barrier
    s_barrier
    s_barrier
L_end:
    s_endpgm
.section .rodata,"a"
.p2align 6
.amdhsa_kernel concat_heads__mha_block_cached__sliding_block_cached__decode_kernel
  .amdhsa_next_free_vgpr 256
  .amdhsa_next_free_sgpr 102
  .amdhsa_accum_offset 256
  .amdhsa_group_segment_fixed_size 0
  .amdhsa_kernarg_size 104
  .amdhsa_user_sgpr_count 2
  .amdhsa_user_sgpr_kernarg_segment_ptr 1
  .amdhsa_system_sgpr_workgroup_id_x 1
  .amdhsa_float_denorm_mode_32 3
.end_amdhsa_kernel
```
